```python
import torch

def _softmax(x, axis=-1):
    return torch.softmax(x, dim=axis)
def _gelu(x):
    return torch.nn.functional.gelu(x, approximate="tanh")
def _silu(x):
    return torch.nn.functional.silu(x)
def _sigmoid(x):
    return torch.sigmoid(x)
def _layernorm(x, axis=-1, eps=1e-5):
    m = x.mean(dim=axis, keepdim=True)
    v = x.var(dim=axis, keepdim=True, unbiased=False)
    return (x - m) / torch.sqrt(v + eps)
def _scatter_add(tgt, idx, src, axis=0):
    return tgt.clone().index_add_(axis, idx, src)
def _segment_sum(src, seg, n):
    out = torch.zeros((n,) + src.shape[1:], dtype=src.dtype)
    return out.index_add_(0, seg, src)
def _pad(x, pw):
    flat = tuple(v for pair in reversed(pw) for v in pair)
    return torch.nn.functional.pad(x, flat)

kernel_name = 'concat_heads__sliding_local_dilated__sliding_block__prompt'

def setup_inputs():

    _w = (lambda a: (lambda t: t.to(torch.bfloat16) if t.is_floating_point() else t)(torch.as_tensor(a)))
    def _A_setup():
        B, S, D = 1, 2048, 640
        return {
            "x": _w((lambda *s: torch.randn(*s, dtype=torch.bfloat16) * 0.2)(B, S, D)),
            "wqkv": _w((lambda *s: torch.randn(*s, dtype=torch.bfloat16) * 0.2)(D, 3 * D)),
            "wo": _w((lambda *s: torch.randn(*s, dtype=torch.bfloat16) * 0.05)(D, D)),
        }
    _A_in = _A_setup()

    def _B_setup():
        B, S, D = 1, 2048, 640
        return {
            "x": _w((lambda *s: torch.randn(*s, dtype=torch.bfloat16) * 0.2)(B, S, D)),
            "wqkv": _w((lambda *s: torch.randn(*s, dtype=torch.bfloat16) * 0.2)(D, 3 * D)),
            "wo": _w((lambda *s: torch.randn(*s, dtype=torch.bfloat16) * 0.05)(D, D)),
        }
    _B_in = _B_setup()

    return {
        "A_x": _A_in["x"],
        "A_wqkv": _A_in["wqkv"],
        "A_wo": _A_in["wo"],
        "B_x": _B_in["x"],
        "B_wqkv": _B_in["wqkv"],
        "B_wo": _B_in["wo"],
    }

def reference(A_x, A_wqkv, A_wo, B_x, B_wqkv, B_wo):
    def _A_ref(x, wqkv, wo):
        B, S, D = x.shape
        H = 32; Dh = D // H
        W, dil = 8, 2
        qkv = (lambda x, *d: x.permute(*d))((x @ wqkv).reshape(B, S, 3, H, Dh), 2, 0, 3, 1, 4)
        q, k, v = qkv[0], qkv[1], qkv[2]
        scale = Dh ** -0.5
        pos = torch.arange(S)
        off = torch.arange(W) * dil
        idx = pos[:, None] - off[None, :]
        mask = idx >= 0
        idx_c = torch.where(mask, idx, 0).reshape(-1)
        kg = k[:, :, idx_c, :].reshape(B, H, S, W, Dh)
        vg = v[:, :, idx_c, :].reshape(B, H, S, W, Dh)
        logits = torch.einsum("bhsd,bhswd->bhsw", q, kg) * scale
        logits = torch.where(mask[None, None, :, :], logits, -1e9)
        attn = _softmax(logits, axis=-1)
        o = torch.einsum("bhsw,bhswd->bhsd", attn, vg)
        return (lambda x, *d: x.permute(*d))(o, 0, 2, 1, 3).reshape(B, S, D) @ wo

    def _B_ref(x, wqkv, wo):
        B, S, D = x.shape
        H = 32; Dh = D // H; W = 256
        qkv = (lambda x, *d: x.permute(*d))((x @ wqkv).reshape(B, S, 3, H, Dh), 2, 0, 3, 1, 4)
        q, k, v = qkv[0], qkv[1], qkv[2]
        scores = torch.einsum("bhqd,bhkd->bhqk", q, k) * (Dh ** -0.5)
        idx = torch.arange(S)
        mask = (idx[:, None] - idx[None, :] >= 0) & (idx[:, None] - idx[None, :] < W)
        scores = torch.where(mask[None, None], scores, -1e9)
        p = _softmax(scores, axis=-1)
        o = torch.einsum("bhqk,bhkd->bhqd", p, v)
        return (lambda x, *d: x.permute(*d))(o, 0, 2, 1, 3).reshape(B, S, D) @ wo

    a = _A_ref(A_x, A_wqkv, A_wo)
    b = _B_ref(B_x, B_wqkv, B_wo)
    return torch.concatenate([a, b], axis=-1)
```

```asm
; @launch grid=(256,1,1) block=(512,1,1) lds=163840
.amdgcn_target "amdgcn-amd-amdhsa--gfx950"
.text
.globl concat_heads__sliding_local_dilated__sliding_block__prompt_kernel
.p2align 8
.type concat_heads__sliding_local_dilated__sliding_block__prompt_kernel,@function
concat_heads__sliding_local_dilated__sliding_block__prompt_kernel:
    s_cmp_ge_u32 s2, 256
    s_cbranch_scc1 K_end
    s_load_dwordx16 s[32:47], s[0:1], 0
    s_load_dwordx2 s[48:49], s[0:1], 64
    s_getpc_b64 s[50:51]
    v_lshrrev_b32 v2, 6, v0
    s_andn2_b32 s3, s2, 7
    v_add_lshl_u32 v3, v2, s3, 7
    v_min_u32 v3, 24608, v3
    v_and_b32 v1, 63, v0
    global_load_dword v254, v3, s[50:51]
    s_and_b32 s3, s2, 7
    s_lshr_b32 s4, s2, 3
    v_readfirstlane_b32 s28, v2
    s_lshr_b32 s5, s3, 2
    s_bfe_u32 s6, s3, 0x10001
    s_and_b32 s7, s3, 1
    s_and_b32 s10, s4, 7
    s_lshr_b32 s11, s4, 3
    s_lshl_b32 s6, s6, 3
    s_add_u32 s6, s6, s10
    s_lshl_b32 s7, s7, 2
    s_add_u32 s7, s7, s11
    s_cmp_lt_u32 s28, 4
    s_cbranch_scc1 P1_consumer
    s_sub_u32 s29, s28, 4
    v_lshrrev_b32 v2, 5, v1
    v_and_b32 v3, 31, v1
    v_mul_u32_u24 v2, 15360, v2
    v_mul_u32_u24 v6, 26, v3
    v_lshrrev_b32 v6, 8, v6
    s_cmp_eq_u32 s5, 0
    s_cselect_b32 s15, 1120, 0
    s_movk_i32 s14, 480
    s_cselect_b32 s14, 160, s14
    v_mul_lo_u32 v6, v6, s15
    v_lshl_add_u32 v2, v3, 4, v2
    v_add_u32 v2, v2, v6
    v_mov_b32 v4, 2147479552
    v_cmp_gt_u32 vcc, 30, v3
    v_lshrrev_b32 v5, 3, v1
    v_mul_u32_u24 v5, 1280, v5
    v_cndmask_b32 v8, v4, v2, vcc
    v_and_b32 v3, 7, v1
    v_lshrrev_b32 v4, 4, v1
    v_xor_b32 v3, v3, v4
    v_lshl_add_u32 v9, v3, 4, v5
    v_xor_b32 v3, 4, v3
    v_lshl_add_u32 v10, v3, 4, v5
    s_add_u32 s12, s10, s11
    s_and_b32 s12, s12, 3
    s_mul_i32 s12, s12, 5
    s_lshr_b32 s12, s12, 1
    s_mul_i32 s13, s29, 30720
    s_mul_i32 s14, s7, s14
    s_add_u32 s13, s13, s14
    s_lshl_b32 s14, s6, 7
    s_lshl_b32 s15, s29, 5
    s_add_u32 s14, s14, s15
    s_mul_i32 s14, s14, 1280
    s_mul_i32 s30, s29, 4224
    s_lshl_b32 s31, s29, 12
    s_add_u32 s31, s31, 33792
    s_mul_i32 s26, s12, 245760
    s_add_u32 s26, s26, s13
    s_lshl_b32 s27, s12, 7
    s_add_u32 s27, s27, s14
    s_mov_b32 s25, 0
    s_mov_b32 s51, 0
    s_cmp_eq_u32 s5, 0
    s_waitcnt lgkmcnt(0)
    s_cselect_b32 s16, s32, s38
    s_cselect_b32 s17, s33, s39
    s_cselect_b32 s20, s34, s40
    s_cselect_b32 s21, s35, s41
    s_and_b32 s17, s17, 0xffff
    s_mov_b32 s18, 2621440
    s_mov_b32 s19, 0x20000
    s_and_b32 s21, s21, 0xffff
    s_mov_b32 s22, 2457600
    s_mov_b32 s23, 0x20000
    s_branch P1_lf
P1_lloop:
    s_add_u32 m0, s30, 2112
    s_add_u32 s50, s26, 7680
    buffer_load_dwordx4 v8, s[20:23], s50 offen lds
    s_add_u32 m0, s30, 3168
    s_add_u32 s50, s26, 11520
    buffer_load_dwordx4 v8, s[20:23], s50 offen lds
    s_add_u32 m0, s30, 16896
    s_add_u32 s50, s26, 122880
    buffer_load_dwordx4 v8, s[20:23], s50 offen lds
    s_add_u32 m0, s30, 17952
    s_add_u32 s50, s26, 126720
    buffer_load_dwordx4 v8, s[20:23], s50 offen lds
    s_add_u32 m0, s30, 19008
    s_add_u32 s50, s26, 130560
    buffer_load_dwordx4 v8, s[20:23], s50 offen lds
    s_add_u32 m0, s30, 20064
    s_add_u32 s50, s26, 134400
    buffer_load_dwordx4 v8, s[20:23], s50 offen lds
    s_add_u32 s12, s12, 1
    s_cmp_eq_u32 s12, 10
    s_cselect_b32 s12, 0, s12
    s_mul_i32 s26, s12, 245760
    s_add_u32 s26, s26, s13
    s_lshl_b32 s27, s12, 7
    s_add_u32 s27, s27, s14
    s_add_u32 s25, s25, 1
    s_cmp_eq_u32 s25, 3
    s_cselect_b32 s25, 0, s25
    s_mov_b32 s50, 50176
    s_cselect_b32 s50, 4294866944, s50
    s_add_u32 s30, s30, s50
    s_add_u32 s31, s31, s50
    s_add_u32 s51, s51, 1
    s_cmp_eq_u32 s51, 10
    s_cbranch_scc1 P1_llast
P1_lf:
    s_add_u32 m0, s31, 0
    s_add_u32 s50, s27, 0
    buffer_load_dwordx4 v9, s[16:19], s50 offen lds
    s_add_u32 m0, s30, 0
    s_add_u32 s50, s26, 0
    buffer_load_dwordx4 v8, s[20:23], s50 offen lds
    s_add_u32 m0, s31, 1024
    s_add_u32 s50, s27, 10240
    buffer_load_dwordx4 v10, s[16:19], s50 offen lds
    s_add_u32 m0, s30, 1056
    s_add_u32 s50, s26, 3840
    buffer_load_dwordx4 v8, s[20:23], s50 offen lds
    s_add_u32 m0, s31, 2048
    s_add_u32 s50, s27, 20480
    buffer_load_dwordx4 v9, s[16:19], s50 offen lds
    s_add_u32 m0, s31, 3072
    s_add_u32 s50, s27, 30720
    buffer_load_dwordx4 v10, s[16:19], s50 offen lds
    s_cmp_eq_u32 s51, 0
    s_cbranch_scc1 P1_lloop
    s_waitcnt vmcnt(6)
    s_barrier
    s_branch P1_lloop
P1_llast:
    s_waitcnt vmcnt(0)
    s_barrier
    s_cmp_lg_u32 s28, 4
    s_cbranch_scc1 EP_skip2
    s_mov_b32 s96, s46
    s_and_b32 s97, s47, 0xffff
    s_mov_b32 s98, 256
    s_mov_b32 s99, 0x20000
    v_mov_b32 v252, 0
    s_mov_b32 s94, 0
EP_spin:
    buffer_load_dwordx2 v[250:251], v252, s[96:99], 0 offen sc1
    s_add_u32 s94, s94, 1
    s_waitcnt vmcnt(0)
    v_readfirstlane_b32 s95, v250
    s_cmp_ge_u32 s94, 131072
    s_cbranch_scc1 EP_got
    s_cmp_eq_u32 s95, 0
    s_cbranch_scc1 EP_spin
EP_got:
    v_mov_b32 v252, 140000
    s_nop 0
    ds_write_b64 v252, v[250:251]
    s_waitcnt lgkmcnt(0)
EP_skip2:
    s_bitcmp0_b32 s2, 2
    s_cselect_b32 s16, s36, s42
    s_cselect_b32 s17, s37, s43
    s_and_b32 s17, s17, 0xffff
    s_mov_b32 s18, 819200
    s_lshr_b32 s12, s2, 3
    s_lshl_b32 s12, s12, 2
    s_add_u32 s12, s12, s29
    s_mul_i32 s12, s12, 6400
    v_lshlrev_b32 v2, 7, v1
    v_mov_b32 v3, 2147479552
    v_cmp_gt_u32 vcc, 50, v1
    s_nop 1
    v_cndmask_b32 v2, v3, v2, vcc
    buffer_load_dword v254, v2, s[16:19], s12 offen
    buffer_load_dword v254, v2, s[16:19], s12 offen offset:64
    v_lshrrev_b32 v5, 5, v1
    v_and_b32 v2, 31, v1
    v_lshlrev_b32 v3, 2, v5
    v_sub_u32 v222, v2, v3
    v_mov_b32 v223, 0xff800000
    v_mov_b32 v227, 0
    v_lshlrev_b32 v224, 4, v1
    v_cmp_le_i32 s[52:53], 0, v222
    v_cmp_le_i32 s[54:55], 1, v222
    v_cmp_le_i32 s[56:57], 2, v222
    v_cmp_le_i32 s[58:59], 3, v222
    v_cmp_le_i32 s[60:61], 8, v222
    v_cmp_le_i32 s[62:63], 9, v222
    v_cmp_le_i32 s[64:65], 10, v222
    v_cmp_le_i32 s[66:67], 11, v222
    v_cmp_le_i32 s[68:69], 16, v222
    v_cmp_le_i32 s[70:71], 17, v222
    v_cmp_le_i32 s[72:73], 18, v222
    v_cmp_le_i32 s[74:75], 19, v222
    v_cmp_le_i32 s[76:77], 24, v222
    v_cmp_le_i32 s[78:79], 25, v222
    v_cmp_le_i32 s[80:81], 26, v222
    v_cmp_le_i32 s[82:83], 27, v222
    v_mov_b32 v2, 0xffff
    v_mov_b32 v3, 0xffff0000
    v_mov_b32 v4, 0
    v_cndmask_b32 v6, v4, v2, s[52:53]
    v_cndmask_b32 v7, v4, v3, s[54:55]
    v_or_b32 v214, v6, v7
    v_cndmask_b32 v6, v4, v2, s[56:57]
    v_cndmask_b32 v7, v4, v3, s[58:59]
    v_or_b32 v215, v6, v7
    v_cndmask_b32 v6, v4, v2, s[60:61]
    v_cndmask_b32 v7, v4, v3, s[62:63]
    v_or_b32 v216, v6, v7
    v_cndmask_b32 v6, v4, v2, s[64:65]
    v_cndmask_b32 v7, v4, v3, s[66:67]
    v_or_b32 v217, v6, v7
    v_cndmask_b32 v6, v4, v2, s[68:69]
    v_cndmask_b32 v7, v4, v3, s[70:71]
    v_or_b32 v218, v6, v7
    v_cndmask_b32 v6, v4, v2, s[72:73]
    v_cndmask_b32 v7, v4, v3, s[74:75]
    v_or_b32 v219, v6, v7
    v_cndmask_b32 v6, v4, v2, s[76:77]
    v_cndmask_b32 v7, v4, v3, s[78:79]
    v_or_b32 v220, v6, v7
    v_cndmask_b32 v6, v4, v2, s[80:81]
    v_cndmask_b32 v7, v4, v3, s[82:83]
    v_or_b32 v221, v6, v7
    v_and_b32 v3, 3, v1
    v_bfe_u32 v4, v1, 2, 2
    v_lshrrev_b32 v7, 1, v3
    v_lshlrev_b32 v7, 6, v7
    v_and_b32 v6, 1, v3
    v_lshl_add_u32 v7, v6, 3, v7
    v_min_u32 v6, 1, v3
    v_lshlrev_b32 v6, 3, v6
    v_add_u32 v6, 128, v6
    v_bfe_u32 v2, v1, 4, 1
    v_cmp_eq_u32 vcc, 0, v2
    v_mul_u32_u24 v2, 20480, v2
    v_and_b32 v3, 15, v1
    v_cndmask_b32 v7, v6, v7, vcc
    v_lshl_add_u32 v7, v4, 4, v7
    v_mul_u32_u24 v6, 192, v5
    v_add_u32 v225, v7, v6
    v_lshl_add_u32 v226, v3, 4, v2
    s_mov_b32 s84, 528482304
    s_mov_b32 s85, 1602224128
    s_mov_b32 s92, 0
    s_mov_b32 s93, 0
    v_and_b32 v3, 15, v1
    v_bfe_u32 v4, v1, 4, 1
    v_lshlrev_b32 v6, 3, v4
    v_mul_u32_u24 v4, 768, v4
    v_lshl_add_u32 v5, v3, 4, v4
    v_lshl_add_u32 v6, v3, 4, v6
    v_add_u32 v6, 504, v6
    v_cmp_gt_u32 vcc, 32, v1
    v_add_u32 v7, 256, v5
    v_add_u32 v8, 1280, v5
    v_add_u32 v9, 1280, v7
    v_add_u32 v10, 1280, v6
    v_cndmask_b32 v12, v7, v5, vcc
    v_cndmask_b32 v13, v8, v6, vcc
    v_cndmask_b32 v14, v10, v9, vcc
    s_mov_b32 s12, 0x15555556
    v_add_u32 v3, 0, v1
    v_mul_hi_u32 v4, v3, s12
    v_mul_u32_u24 v5, 12, v4
    v_sub_u32 v5, v3, v5
    v_lshrrev_b32 v6, 2, v5
    v_and_b32 v5, 3, v5
    v_lshl_add_u32 v5, v4, 2, v5
    v_lshrrev_b32 v7, 5, v5
    v_mul_u32_u24 v7, 1280, v7
    v_lshrrev_b32 v9, 1, v6
    v_mul_u32_u24 v9, 760, v9
    v_sub_u32 v9, 768, v9
    v_bfe_u32 v8, v5, 4, 1
    v_mad_u32_u24 v7, v8, v9, v7
    v_and_b32 v5, 15, v5
    v_lshl_add_u32 v7, v5, 4, v7
    v_lshl_add_u32 v15, v6, 8, v7
    v_add_u32 v3, 64, v1
    v_mul_hi_u32 v4, v3, s12
    v_mul_u32_u24 v5, 12, v4
    v_sub_u32 v5, v3, v5
    v_lshrrev_b32 v6, 2, v5
    v_and_b32 v5, 3, v5
    v_lshl_add_u32 v5, v4, 2, v5
    v_lshrrev_b32 v7, 5, v5
    v_mul_u32_u24 v7, 1280, v7
    v_lshrrev_b32 v9, 1, v6
    v_mul_u32_u24 v9, 760, v9
    v_sub_u32 v9, 768, v9
    v_bfe_u32 v8, v5, 4, 1
    v_mad_u32_u24 v7, v8, v9, v7
    v_and_b32 v5, 15, v5
    v_lshl_add_u32 v7, v5, 4, v7
    v_lshl_add_u32 v16, v6, 8, v7
    v_add_u32 v3, 128, v1
    v_mul_hi_u32 v4, v3, s12
    v_mul_u32_u24 v5, 12, v4
    v_sub_u32 v5, v3, v5
    v_lshrrev_b32 v6, 2, v5
    v_and_b32 v5, 3, v5
    v_lshl_add_u32 v5, v4, 2, v5
    v_lshrrev_b32 v7, 5, v5
    v_mul_u32_u24 v7, 1280, v7
    v_lshrrev_b32 v9, 1, v6
    v_mul_u32_u24 v9, 760, v9
    v_sub_u32 v9, 768, v9
    v_bfe_u32 v8, v5, 4, 1
    v_mad_u32_u24 v7, v8, v9, v7
    v_and_b32 v5, 15, v5
    v_lshl_add_u32 v7, v5, 4, v7
    v_lshl_add_u32 v17, v6, 8, v7
    s_add_u32 s94, s48, 25165824
    s_addc_u32 s95, s49, 0
    s_mov_b32 s96, s94
    s_and_b32 s97, s95, 0xffff
    s_mov_b32 s98, 262144
    s_mov_b32 s99, 0x20000
    s_and_b32 s3, s2, 7
    s_lshl_b32 s3, s3, 2
    s_bfe_u32 s4, s2, 0x20003
    s_or_b32 s3, s3, s4
    s_lshr_b32 s4, s2, 5
    v_subrev_u32 v228, 0, v222
    v_and_b32 v228, 17, v228
    v_cmp_eq_u32 s[88:89], 0, v228
    s_nop 1
    v_cndmask_b32 v230, v223, v227, s[88:89]
    v_subrev_u32 v228, 1, v222
    v_and_b32 v228, 17, v228
    v_cmp_eq_u32 s[88:89], 0, v228
    s_nop 1
    v_cndmask_b32 v231, v223, v227, s[88:89]
    v_subrev_u32 v228, 2, v222
    v_and_b32 v228, 17, v228
    v_cmp_eq_u32 s[88:89], 0, v228
    s_nop 1
    v_cndmask_b32 v232, v223, v227, s[88:89]
    v_subrev_u32 v228, 3, v222
    v_and_b32 v228, 17, v228
    v_cmp_eq_u32 s[88:89], 0, v228
    s_nop 1
    v_cndmask_b32 v233, v223, v227, s[88:89]
    v_subrev_u32 v228, 8, v222
    v_and_b32 v228, 17, v228
    v_cmp_eq_u32 s[88:89], 0, v228
    s_nop 1
    v_cndmask_b32 v234, v223, v227, s[88:89]
    v_subrev_u32 v228, 9, v222
    v_and_b32 v228, 17, v228
    v_cmp_eq_u32 s[88:89], 0, v228
    s_nop 1
    v_cndmask_b32 v235, v223, v227, s[88:89]
    v_subrev_u32 v228, 10, v222
    v_and_b32 v228, 17, v228
    v_cmp_eq_u32 s[88:89], 0, v228
    s_nop 1
    v_cndmask_b32 v236, v223, v227, s[88:89]
    v_subrev_u32 v228, 11, v222
    v_and_b32 v228, 17, v228
    v_cmp_eq_u32 s[88:89], 0, v228
    s_nop 1
    v_cndmask_b32 v237, v223, v227, s[88:89]
    v_subrev_u32 v228, 16, v222
    v_and_b32 v228, 17, v228
    v_cmp_eq_u32 s[88:89], 0, v228
    s_nop 1
    v_cndmask_b32 v238, v223, v227, s[88:89]
    v_subrev_u32 v228, 17, v222
    v_and_b32 v228, 17, v228
    v_cmp_eq_u32 s[88:89], 0, v228
    s_nop 1
    v_cndmask_b32 v239, v223, v227, s[88:89]
    v_subrev_u32 v228, 18, v222
    v_and_b32 v228, 17, v228
    v_cmp_eq_u32 s[88:89], 0, v228
    s_nop 1
    v_cndmask_b32 v240, v223, v227, s[88:89]
    v_subrev_u32 v228, 19, v222
    v_and_b32 v228, 17, v228
    v_cmp_eq_u32 s[88:89], 0, v228
    s_nop 1
    v_cndmask_b32 v241, v223, v227, s[88:89]
    v_subrev_u32 v228, 24, v222
    v_and_b32 v228, 17, v228
    v_cmp_eq_u32 s[88:89], 0, v228
    s_nop 1
    v_cndmask_b32 v242, v223, v227, s[88:89]
    v_subrev_u32 v228, 25, v222
    v_and_b32 v228, 17, v228
    v_cmp_eq_u32 s[88:89], 0, v228
    s_nop 1
    v_cndmask_b32 v243, v223, v227, s[88:89]
    v_subrev_u32 v228, 26, v222
    v_and_b32 v228, 17, v228
    v_cmp_eq_u32 s[88:89], 0, v228
    s_nop 1
    v_cndmask_b32 v244, v223, v227, s[88:89]
    v_subrev_u32 v228, 27, v222
    v_and_b32 v228, 17, v228
    v_cmp_eq_u32 s[88:89], 0, v228
    s_nop 1
    v_cndmask_b32 v245, v223, v227, s[88:89]
    v_cmp_lt_u32 vcc, 11, v1
    v_mov_b32 v2, 0
    v_mov_b32 v3, 1
    v_cndmask_b32 v2, v2, v3, vcc
    v_mul_u32_u24 v3, 12, v2
    v_sub_u32 v3, v1, v3
    s_mul_i32 s12, s7, 12
    v_add_u32 v3, s12, v3
    v_lshrrev_b32 v4, 5, v3
    v_and_b32 v3, 31, v3
    s_lshr_b32 s12, s6, 1
    v_add_u32 v5, s12, v2
    v_lshl_add_u32 v3, v5, 5, v3
    s_and_b32 s12, s6, 1
    s_add_u32 s12, s12, 2
    v_lshlrev_b32 v2, 1, v2
    v_sub_u32 v2, s12, v2
    v_lshl_add_u32 v2, v2, 4, v4
    v_lshlrev_b32 v2, 3, v2
    v_lshl_add_u32 v2, v3, 9, v2
    v_cmp_gt_u32 vcc, 8, v5
    v_cmp_gt_u32 s[88:89], 24, v1
    v_mov_b32 v3, 2147479552
    s_and_b64 vcc, vcc, s[88:89]
    s_cmp_lg_u32 s28, 4
    s_cselect_b64 vcc, 0, vcc
    s_nop 0
    v_cndmask_b32 v18, v3, v2, vcc
    s_lshl_b32 s12, s4, 5
    s_add_u32 s12, s12, s3
    s_lshl_b32 s12, s12, 9
    s_lshl_b32 s13, s29, 7
    s_add_u32 s12, s12, s13
    s_add_u32 s40, s12, 25165824
    s_lshl_b32 s13, s29, 3
    s_mul_i32 s14, s3, 128
    s_lshl_b32 s15, s4, 4
    s_add_u32 s14, s14, s15
    s_add_u32 s14, s14, s13
    s_sub_u32 s14, s14, 16
    s_mul_i32 s26, s14, 640
    s_mul_i32 s27, s14, 640
    s_add_u32 s27, s27, 5242880
    s_add_u32 s15, s15, s13
    s_cmp_lt_u32 s15, 16
    s_cselect_b32 s26, 0x70000000, s26
    s_cselect_b32 s27, 0x70000000, s27
    s_cselect_b32 s31, 7, 0
    s_cmp_ge_u32 s29, 2
    s_cselect_b32 s30, 7, 6
    s_mul_i32 s25, s29, 6144
    v_lshrrev_b32 v52, 2, v1
    v_mul_u32_u24 v52, 192, v52
    v_and_b32 v53, 3, v1
    v_lshl_add_u32 v52, v53, 4, v52
    s_add_u32 s12, s25, 24712
    v_add_u32 v53, s12, v52
    s_mul_i32 s12, s29, 21504
    s_add_u32 s12, s12, 64136
    v_add_u32 v52, s12, v52
    v_mov_b32 v54, 0x3f803f80
    v_mov_b32 v55, 0x3f803f80
    s_mov_b64 s[46:47], s[36:37]
    s_cmp_eq_u32 s6, 0
    s_cselect_b32 s12, 8, 0
    s_or_b32 s31, s31, s12
    s_cmp_eq_u32 s5, 0
    s_cselect_b32 s12, 8, 0
    s_or_b32 s30, s30, s12
    s_add_u32 s12, s48, 7864320
    s_addc_u32 s13, s49, 0
    s_mov_b32 s20, s12
    s_and_b32 s21, s13, 0xffff
    s_mov_b32 s22, 7864320
    s_mov_b32 s23, 0x20000
    s_mov_b32 s16, s48
    s_and_b32 s17, s49, 0xffff
    s_mov_b32 s18, 7864320
    s_mov_b32 s19, 0x20000
    s_cmp_eq_u32 s5, 0
    s_cbranch_scc0 L_x1
    s_barrier
L_x1:
    s_mov_b32 s12, 0x1999999a
    v_add_u32 v8, 0, v1
    v_mul_hi_u32 v9, v8, s12
    v_mul_u32_u24 v10, 10, v9
    v_sub_u32 v10, v8, v10
    v_bfe_u32 v11, v9, 2, 2
    v_lshlrev_b32 v11, 3, v11
    v_bfe_u32 v7, v9, 4, 1
    v_lshl_add_u32 v11, v7, 2, v11
    v_and_b32 v7, 3, v9
    v_add_u32 v11, v11, v7
    v_lshrrev_b32 v7, 4, v11
    v_lshl_add_u32 v7, v7, 2, v11
    v_mul_u32_u24 v7, 1280, v7
    v_lshl_add_u32 v36, v10, 4, v7
    v_mov_b32 v41, v36
    v_add_u32 v8, 64, v1
    v_mul_hi_u32 v9, v8, s12
    v_mul_u32_u24 v10, 10, v9
    v_sub_u32 v10, v8, v10
    v_bfe_u32 v11, v9, 2, 2
    v_lshlrev_b32 v11, 3, v11
    v_bfe_u32 v7, v9, 4, 1
    v_lshl_add_u32 v11, v7, 2, v11
    v_and_b32 v7, 3, v9
    v_add_u32 v11, v11, v7
    v_lshrrev_b32 v7, 4, v11
    v_lshl_add_u32 v7, v7, 2, v11
    v_mul_u32_u24 v7, 1280, v7
    v_lshl_add_u32 v37, v10, 4, v7
    v_mov_b32 v42, v37
    v_add_u32 v8, 128, v1
    v_mul_hi_u32 v9, v8, s12
    v_mul_u32_u24 v10, 10, v9
    v_sub_u32 v10, v8, v10
    v_bfe_u32 v11, v9, 2, 2
    v_lshlrev_b32 v11, 3, v11
    v_bfe_u32 v7, v9, 4, 1
    v_lshl_add_u32 v11, v7, 2, v11
    v_and_b32 v7, 3, v9
    v_add_u32 v11, v11, v7
    v_lshrrev_b32 v7, 4, v11
    v_lshl_add_u32 v7, v7, 2, v11
    v_mul_u32_u24 v7, 1280, v7
    v_lshl_add_u32 v38, v10, 4, v7
    v_mov_b32 v43, v38
    v_add_u32 v8, 192, v1
    v_mul_hi_u32 v9, v8, s12
    v_mul_u32_u24 v10, 10, v9
    v_sub_u32 v10, v8, v10
    v_bfe_u32 v11, v9, 2, 2
    v_lshlrev_b32 v11, 3, v11
    v_bfe_u32 v7, v9, 4, 1
    v_lshl_add_u32 v11, v7, 2, v11
    v_and_b32 v7, 3, v9
    v_add_u32 v11, v11, v7
    v_lshrrev_b32 v7, 4, v11
    v_lshl_add_u32 v7, v7, 2, v11
    v_mul_u32_u24 v7, 1280, v7
    v_lshl_add_u32 v39, v10, 4, v7
    v_mov_b32 v44, v39
    v_add_u32 v8, 256, v1
    v_mul_hi_u32 v9, v8, s12
    v_mul_u32_u24 v10, 10, v9
    v_sub_u32 v10, v8, v10
    v_bfe_u32 v11, v9, 2, 2
    v_lshlrev_b32 v11, 3, v11
    v_bfe_u32 v7, v9, 4, 1
    v_lshl_add_u32 v11, v7, 2, v11
    v_and_b32 v7, 3, v9
    v_add_u32 v11, v11, v7
    v_lshrrev_b32 v7, 4, v11
    v_lshl_add_u32 v7, v7, 2, v11
    v_mul_u32_u24 v7, 1280, v7
    v_lshl_add_u32 v40, v10, 4, v7
    v_mov_b32 v45, v40
    s_cmp_eq_u32 s4, 0
    s_cselect_b64 s[88:89], exec, 0
    s_nop 1
    v_cndmask_b32 v80, v227, v223, s[88:89]
    v_cndmask_b32 v81, v227, v223, s[88:89]
    v_cndmask_b32 v82, v227, v223, s[88:89]
    v_cndmask_b32 v83, v227, v223, s[88:89]
    v_cndmask_b32 v84, v227, v223, s[88:89]
    v_cndmask_b32 v85, v227, v223, s[88:89]
    v_cndmask_b32 v86, v227, v223, s[88:89]
    v_cndmask_b32 v87, v227, v223, s[88:89]
    v_cndmask_b32 v88, v227, v223, s[88:89]
    v_cndmask_b32 v89, v227, v223, s[88:89]
    v_cndmask_b32 v90, v227, v223, s[88:89]
    v_cndmask_b32 v91, v227, v223, s[88:89]
    v_cndmask_b32 v92, v227, v223, s[88:89]
    v_cndmask_b32 v93, v227, v223, s[88:89]
    v_cndmask_b32 v94, v227, v223, s[88:89]
    v_cndmask_b32 v95, v227, v223, s[88:89]
    s_lshl_b32 s12, s4, 4
    s_add_u32 s12, s12, 128
    v_add_u32 v2, s12, v1
    v_lshlrev_b32 v2, 9, v2
    s_lshl_b32 s12, s3, 3
    s_and_b32 s13, s3, 24
    s_lshl_b32 s13, s13, 3
    s_add_u32 s12, s12, s13
    s_add_u32 s12, s12, 131072
    v_add_u32 v2, s12, v2
    v_mov_b32 v3, 2147479552
    v_cmp_gt_u32 vcc, 16, v1
    v_mov_b32 v58, v3
    v_mov_b32 v59, v3
    v_cndmask_b32 v19, v3, v2, vcc
    s_cmp_eq_u32 s5, 0
    s_cbranch_scc1 L_x2
    s_barrier
    buffer_store_dwordx2 v[250:251], v18, s[96:99], 0 offen sc1
L_x2:
    v_mov_b32 v252, 140000
    s_nop 0
    ds_read_b64 v[250:251], v252
    s_waitcnt lgkmcnt(0)
    v_readfirstlane_b32 s0, v250
    v_readfirstlane_b32 s1, v251
    s_mov_b32 s11, 0
PL_b:
    s_load_dwordx8 s[32:39], s[48:49], s40 glc
PL_b2:
    s_add_u32 s11, s11, 1
    s_cmp_ge_u32 s11, 131072
    s_cselect_b32 s12, 15, s31
    s_waitcnt lgkmcnt(0)
    s_cmp_eq_u64 s[32:33], s[0:1]
    s_cselect_b32 s13, 1, 0
    s_or_b32 s12, s12, s13
    s_cmp_eq_u64 s[34:35], s[0:1]
    s_cselect_b32 s13, 2, 0
    s_or_b32 s12, s12, s13
    s_cmp_eq_u64 s[36:37], s[0:1]
    s_cselect_b32 s13, 4, 0
    s_or_b32 s12, s12, s13
    s_cmp_eq_u64 s[38:39], s[0:1]
    s_cselect_b32 s13, 8, 0
    s_or_b32 s12, s12, s13
    s_and_b32 s12, s12, s30
    s_bitcmp1_b32 s12, 3
    s_cbranch_scc0 PB_h
    s_mov_b64 s[90:91], exec
    s_lshl_b32 s15, s7, 2
    s_add_u32 s15, s15, s29
    s_mul_i32 s15, s15, 128
    s_lshl_b32 s13, s6, 3
    s_add_u32 s15, s15, s13
    s_sub_u32 s15, s15, 2
    s_mul_i32 s14, s29, 21504
    s_mul_i32 s13, s15, 640
    s_add_u32 s13, s13, 2621440
    s_cmp_eq_u32 s6, 0
    s_cselect_b32 s13, 0x70000000, s13
    s_add_u32 m0, s14, 50176
    s_nop 0
    buffer_load_dwordx4 v12, s[16:19], s13 offen sc1 lds
    s_add_u32 m0, s14, 51200
    s_mov_b32 exec_hi, 0
    buffer_load_dwordx4 v13, s[16:19], s13 offen sc1 lds
    s_mov_b64 exec, s[90:91]
    s_mul_i32 s13, s15, 640
    s_add_u32 s13, s13, 5242880
    s_cmp_eq_u32 s6, 0
    s_cselect_b32 s13, 0x70000000, s13
    s_add_u32 m0, s14, 64000
    s_nop 0
    buffer_load_dwordx4 v15, s[16:19], s13 offen sc1 lds
    s_add_u32 m0, s14, 65024
    s_mov_b32 exec_hi, 0
    buffer_load_dwordx4 v16, s[16:19], s13 offen sc1 lds
    s_mov_b64 exec, s[90:91]
PB_h:
    s_bitcmp1_b32 s12, 0
    s_cbranch_scc0 PB_0
    s_add_u32 s13, s26, 0
    s_add_u32 m0, s25, 139264
    s_nop 0
    buffer_load_dwordx4 v12, s[20:23], s13 offen sc1 lds
    s_add_u32 m0, s25, 140288
    s_nop 0
    buffer_load_dwordx4 v13, s[20:23], s13 offen sc1 lds
    s_add_u32 m0, s25, 141312
    s_nop 0
    buffer_load_dwordx4 v14, s[20:23], s13 offen sc1 lds
    s_add_u32 s13, s26, 2560
    s_add_u32 m0, s25, 142336
    s_nop 0
    buffer_load_dwordx4 v12, s[20:23], s13 offen sc1 lds
    s_add_u32 m0, s25, 143360
    s_nop 0
    buffer_load_dwordx4 v13, s[20:23], s13 offen sc1 lds
    s_add_u32 m0, s25, 144384
    s_nop 0
    buffer_load_dwordx4 v14, s[20:23], s13 offen sc1 lds
PB_0:
    s_bitcmp1_b32 s12, 1
    s_cbranch_scc0 PB_1
    s_add_u32 s13, s26, 2621440
    s_add_u32 m0, s25, 0
    s_nop 0
    buffer_load_dwordx4 v12, s[20:23], s13 offen sc1 lds
    s_add_u32 m0, s25, 1024
    s_nop 0
    buffer_load_dwordx4 v13, s[20:23], s13 offen sc1 lds
    s_add_u32 m0, s25, 2048
    s_nop 0
    buffer_load_dwordx4 v14, s[20:23], s13 offen sc1 lds
    s_add_u32 s13, s26, 2624000
    s_add_u32 m0, s25, 3072
    s_nop 0
    buffer_load_dwordx4 v12, s[20:23], s13 offen sc1 lds
    s_add_u32 m0, s25, 4096
    s_nop 0
    buffer_load_dwordx4 v13, s[20:23], s13 offen sc1 lds
    s_add_u32 m0, s25, 5120
    s_nop 0
    buffer_load_dwordx4 v14, s[20:23], s13 offen sc1 lds
PB_1:
    s_bitcmp1_b32 s12, 2
    s_cbranch_scc0 PB_2
    s_add_u32 s13, s27, 0
    s_add_u32 m0, s25, 24576
    s_nop 0
    buffer_load_dwordx4 v15, s[20:23], s13 offen sc1 lds
    s_add_u32 m0, s25, 25600
    s_nop 0
    buffer_load_dwordx4 v16, s[20:23], s13 offen sc1 lds
    s_add_u32 m0, s25, 26624
    s_nop 0
    buffer_load_dwordx4 v17, s[20:23], s13 offen sc1 lds
    s_add_u32 s13, s27, 2560
    s_add_u32 m0, s25, 27648
    s_nop 0
    buffer_load_dwordx4 v15, s[20:23], s13 offen sc1 lds
    s_add_u32 m0, s25, 28672
    s_nop 0
    buffer_load_dwordx4 v16, s[20:23], s13 offen sc1 lds
    s_add_u32 m0, s25, 29696
    s_nop 0
    buffer_load_dwordx4 v17, s[20:23], s13 offen sc1 lds
PB_2:
    s_andn2_b32 s30, s30, s12
    s_bitcmp1_b32 s12, 3
    s_cbranch_scc0 L_nh
    s_mov_b32 s8, s25
    s_mov_b32 s9, s26
    s_mov_b32 s10, s27
    s_mov_b32 s15, s29
    s_mov_b32 s16, 0
    s_add_u32 s12, s48, 18874368
    s_addc_u32 s13, s49, 0
    s_waitcnt vmcnt(0)
    ds_write_b64 v52, v[54:55]
    s_branch P2_a_enter
L_Aret:
    s_mov_b32 s25, s8
    s_mov_b32 s26, s9
    s_mov_b32 s27, s10
    s_branch PL_b2
L_nh:
    s_cmp_lg_u32 s30, 0
    s_cbranch_scc0 PD_b
    s_branch PL_b
PD_b:
    s_branch P2_pre
P1_consumer:
    s_or_b32 s96, s28, s2
    s_cbranch_scc1 EP_skip
    s_memrealtime s[94:95]
    v_mov_b32 v252, 0
    s_waitcnt lgkmcnt(0)
    s_mov_b32 s96, s46
    s_and_b32 s97, s47, 0xffff
    s_mov_b32 s98, 256
    s_mov_b32 s99, 0x20000
    s_or_b32 s94, s94, 1
    v_mov_b32 v250, s94
    v_mov_b32 v251, s95
    s_nop 0
    buffer_store_dwordx2 v[250:251], v252, s[96:99], 0 offen sc1
EP_skip:
    v_lshrrev_b32 v2, 2, v1
    v_mul_u32_u24 v2, 1056, v2
    v_and_b32 v3, 3, v1
    v_mul_u32_u24 v3, 40, v3
    v_add_u32 v184, v2, v3
    v_and_b32 v2, 15, v1
    v_lshrrev_b32 v3, 4, v1
    v_lshrrev_b32 v4, 1, v2
    v_xor_b32 v3, v3, v4
    s_lshl_b32 s12, s28, 12
    s_add_u32 s12, s12, 33792
    v_lshlrev_b32 v2, 7, v2
    v_add_u32 v2, s12, v2
    v_lshl_add_u32 v185, v3, 4, v2
    v_xor_b32 v3, 4, v3
    v_lshl_add_u32 v186, v3, 4, v2
    v_mov_b32 v187, v184
    v_mov_b32 v188, v185
    v_mov_b32 v189, v186
    v_pk_mov_b32 v[8:9], 0, 0
    v_pk_mov_b32 v[10:11], 0, 0
    v_pk_mov_b32 v[12:13], 0, 0
    v_pk_mov_b32 v[14:15], 0, 0
    v_pk_mov_b32 v[16:17], 0, 0
    v_pk_mov_b32 v[18:19], 0, 0
    v_pk_mov_b32 v[20:21], 0, 0
    v_pk_mov_b32 v[22:23], 0, 0
    v_pk_mov_b32 v[24:25], 0, 0
    v_pk_mov_b32 v[26:27], 0, 0
    v_pk_mov_b32 v[28:29], 0, 0
    v_pk_mov_b32 v[30:31], 0, 0
    v_pk_mov_b32 v[32:33], 0, 0
    v_pk_mov_b32 v[34:35], 0, 0
    v_pk_mov_b32 v[36:37], 0, 0
    v_pk_mov_b32 v[38:39], 0, 0
    v_pk_mov_b32 v[40:41], 0, 0
    v_pk_mov_b32 v[42:43], 0, 0
    v_pk_mov_b32 v[44:45], 0, 0
    v_pk_mov_b32 v[46:47], 0, 0
    v_pk_mov_b32 v[48:49], 0, 0
    v_pk_mov_b32 v[50:51], 0, 0
    v_pk_mov_b32 v[52:53], 0, 0
    v_pk_mov_b32 v[54:55], 0, 0
    v_pk_mov_b32 v[56:57], 0, 0
    v_pk_mov_b32 v[58:59], 0, 0
    v_pk_mov_b32 v[60:61], 0, 0
    v_pk_mov_b32 v[62:63], 0, 0
    v_pk_mov_b32 v[64:65], 0, 0
    v_pk_mov_b32 v[66:67], 0, 0
    v_pk_mov_b32 v[68:69], 0, 0
    v_pk_mov_b32 v[70:71], 0, 0
    v_pk_mov_b32 v[72:73], 0, 0
    v_pk_mov_b32 v[74:75], 0, 0
    v_pk_mov_b32 v[76:77], 0, 0
    v_pk_mov_b32 v[78:79], 0, 0
    v_pk_mov_b32 v[80:81], 0, 0
    v_pk_mov_b32 v[82:83], 0, 0
    v_pk_mov_b32 v[84:85], 0, 0
    v_pk_mov_b32 v[86:87], 0, 0
    v_pk_mov_b32 v[88:89], 0, 0
    v_pk_mov_b32 v[90:91], 0, 0
    v_pk_mov_b32 v[92:93], 0, 0
    v_pk_mov_b32 v[94:95], 0, 0
    v_pk_mov_b32 v[96:97], 0, 0
    v_pk_mov_b32 v[98:99], 0, 0
    v_pk_mov_b32 v[100:101], 0, 0
    v_pk_mov_b32 v[102:103], 0, 0
    v_pk_mov_b32 v[104:105], 0, 0
    v_pk_mov_b32 v[106:107], 0, 0
    v_pk_mov_b32 v[108:109], 0, 0
    v_pk_mov_b32 v[110:111], 0, 0
    v_pk_mov_b32 v[112:113], 0, 0
    v_pk_mov_b32 v[114:115], 0, 0
    v_pk_mov_b32 v[116:117], 0, 0
    v_pk_mov_b32 v[118:119], 0, 0
    v_pk_mov_b32 v[120:121], 0, 0
    v_pk_mov_b32 v[122:123], 0, 0
    v_pk_mov_b32 v[124:125], 0, 0
    v_pk_mov_b32 v[126:127], 0, 0
    v_pk_mov_b32 v[128:129], 0, 0
    v_pk_mov_b32 v[130:131], 0, 0
    v_pk_mov_b32 v[132:133], 0, 0
    v_pk_mov_b32 v[134:135], 0, 0
    v_pk_mov_b32 v[136:137], 0, 0
    v_pk_mov_b32 v[138:139], 0, 0
    v_pk_mov_b32 v[140:141], 0, 0
    v_pk_mov_b32 v[142:143], 0, 0
    v_pk_mov_b32 v[144:145], 0, 0
    v_pk_mov_b32 v[146:147], 0, 0
    v_pk_mov_b32 v[148:149], 0, 0
    v_pk_mov_b32 v[150:151], 0, 0
    v_pk_mov_b32 v[152:153], 0, 0
    v_pk_mov_b32 v[154:155], 0, 0
    v_pk_mov_b32 v[156:157], 0, 0
    v_pk_mov_b32 v[158:159], 0, 0
    v_pk_mov_b32 v[160:161], 0, 0
    v_pk_mov_b32 v[162:163], 0, 0
    v_pk_mov_b32 v[164:165], 0, 0
    v_pk_mov_b32 v[166:167], 0, 0
    v_pk_mov_b32 v[168:169], 0, 0
    v_pk_mov_b32 v[170:171], 0, 0
    v_pk_mov_b32 v[172:173], 0, 0
    v_pk_mov_b32 v[174:175], 0, 0
    v_pk_mov_b32 v[176:177], 0, 0
    v_pk_mov_b32 v[178:179], 0, 0
    v_pk_mov_b32 v[180:181], 0, 0
    v_pk_mov_b32 v[182:183], 0, 0
    v_lshrrev_b32 v5, 5, v1
    v_and_b32 v2, 31, v1
    v_lshlrev_b32 v3, 2, v5
    v_sub_u32 v222, v2, v3
    v_mov_b32 v223, 0xff800000
    v_mov_b32 v227, 0
    v_lshlrev_b32 v224, 4, v1
    v_cmp_le_i32 s[52:53], 0, v222
    v_cmp_le_i32 s[54:55], 1, v222
    v_cmp_le_i32 s[56:57], 2, v222
    v_cmp_le_i32 s[58:59], 3, v222
    v_cmp_le_i32 s[60:61], 8, v222
    v_cmp_le_i32 s[62:63], 9, v222
    v_cmp_le_i32 s[64:65], 10, v222
    v_cmp_le_i32 s[66:67], 11, v222
    v_cmp_le_i32 s[68:69], 16, v222
    v_cmp_le_i32 s[70:71], 17, v222
    v_cmp_le_i32 s[72:73], 18, v222
    v_cmp_le_i32 s[74:75], 19, v222
    v_cmp_le_i32 s[76:77], 24, v222
    v_cmp_le_i32 s[78:79], 25, v222
    v_cmp_le_i32 s[80:81], 26, v222
    v_cmp_le_i32 s[82:83], 27, v222
    v_mov_b32 v2, 0xffff
    v_mov_b32 v3, 0xffff0000
    v_mov_b32 v4, 0
    v_cndmask_b32 v6, v4, v2, s[52:53]
    v_cndmask_b32 v7, v4, v3, s[54:55]
    v_or_b32 v214, v6, v7
    v_cndmask_b32 v6, v4, v2, s[56:57]
    v_cndmask_b32 v7, v4, v3, s[58:59]
    v_or_b32 v215, v6, v7
    v_cndmask_b32 v6, v4, v2, s[60:61]
    v_cndmask_b32 v7, v4, v3, s[62:63]
    v_or_b32 v216, v6, v7
    v_cndmask_b32 v6, v4, v2, s[64:65]
    v_cndmask_b32 v7, v4, v3, s[66:67]
    v_or_b32 v217, v6, v7
    v_cndmask_b32 v6, v4, v2, s[68:69]
    v_cndmask_b32 v7, v4, v3, s[70:71]
    v_or_b32 v218, v6, v7
    v_cndmask_b32 v6, v4, v2, s[72:73]
    v_cndmask_b32 v7, v4, v3, s[74:75]
    v_or_b32 v219, v6, v7
    v_cndmask_b32 v6, v4, v2, s[76:77]
    v_cndmask_b32 v7, v4, v3, s[78:79]
    v_or_b32 v220, v6, v7
    v_cndmask_b32 v6, v4, v2, s[80:81]
    v_cndmask_b32 v7, v4, v3, s[82:83]
    v_or_b32 v221, v6, v7
    v_and_b32 v3, 3, v1
    v_bfe_u32 v4, v1, 2, 2
    v_lshrrev_b32 v7, 1, v3
    v_lshlrev_b32 v7, 6, v7
    v_and_b32 v6, 1, v3
    v_lshl_add_u32 v7, v6, 3, v7
    v_min_u32 v6, 1, v3
    v_lshlrev_b32 v6, 3, v6
    v_add_u32 v6, 128, v6
    v_bfe_u32 v2, v1, 4, 1
    v_cmp_eq_u32 vcc, 0, v2
    v_mul_u32_u24 v2, 20480, v2
    v_and_b32 v3, 15, v1
    v_cndmask_b32 v7, v6, v7, vcc
    v_lshl_add_u32 v7, v4, 4, v7
    v_mul_u32_u24 v6, 192, v5
    v_add_u32 v225, v7, v6
    v_lshl_add_u32 v226, v3, 4, v2
    s_mov_b32 s84, 528482304
    s_mov_b32 s85, 1602224128
    s_mov_b32 s92, 0
    s_mov_b32 s93, 0
    v_subrev_u32 v228, 0, v222
    v_and_b32 v228, 17, v228
    v_cmp_eq_u32 s[88:89], 0, v228
    s_nop 1
    v_cndmask_b32 v230, v223, v227, s[88:89]
    v_subrev_u32 v228, 1, v222
    v_and_b32 v228, 17, v228
    v_cmp_eq_u32 s[88:89], 0, v228
    s_nop 1
    v_cndmask_b32 v231, v223, v227, s[88:89]
    v_subrev_u32 v228, 2, v222
    v_and_b32 v228, 17, v228
    v_cmp_eq_u32 s[88:89], 0, v228
    s_nop 1
    v_cndmask_b32 v232, v223, v227, s[88:89]
    v_subrev_u32 v228, 3, v222
    v_and_b32 v228, 17, v228
    v_cmp_eq_u32 s[88:89], 0, v228
    s_nop 1
    v_cndmask_b32 v233, v223, v227, s[88:89]
    v_subrev_u32 v228, 8, v222
    v_and_b32 v228, 17, v228
    v_cmp_eq_u32 s[88:89], 0, v228
    s_nop 1
    v_cndmask_b32 v234, v223, v227, s[88:89]
    v_subrev_u32 v228, 9, v222
    v_and_b32 v228, 17, v228
    v_cmp_eq_u32 s[88:89], 0, v228
    s_nop 1
    v_cndmask_b32 v235, v223, v227, s[88:89]
    v_subrev_u32 v228, 10, v222
    v_and_b32 v228, 17, v228
    v_cmp_eq_u32 s[88:89], 0, v228
    s_nop 1
    v_cndmask_b32 v236, v223, v227, s[88:89]
    v_subrev_u32 v228, 11, v222
    v_and_b32 v228, 17, v228
    v_cmp_eq_u32 s[88:89], 0, v228
    s_nop 1
    v_cndmask_b32 v237, v223, v227, s[88:89]
    v_subrev_u32 v228, 16, v222
    v_and_b32 v228, 17, v228
    v_cmp_eq_u32 s[88:89], 0, v228
    s_nop 1
    v_cndmask_b32 v238, v223, v227, s[88:89]
    v_subrev_u32 v228, 17, v222
    v_and_b32 v228, 17, v228
    v_cmp_eq_u32 s[88:89], 0, v228
    s_nop 1
    v_cndmask_b32 v239, v223, v227, s[88:89]
    v_subrev_u32 v228, 18, v222
    v_and_b32 v228, 17, v228
    v_cmp_eq_u32 s[88:89], 0, v228
    s_nop 1
    v_cndmask_b32 v240, v223, v227, s[88:89]
    v_subrev_u32 v228, 19, v222
    v_and_b32 v228, 17, v228
    v_cmp_eq_u32 s[88:89], 0, v228
    s_nop 1
    v_cndmask_b32 v241, v223, v227, s[88:89]
    v_subrev_u32 v228, 24, v222
    v_and_b32 v228, 17, v228
    v_cmp_eq_u32 s[88:89], 0, v228
    s_nop 1
    v_cndmask_b32 v242, v223, v227, s[88:89]
    v_subrev_u32 v228, 25, v222
    v_and_b32 v228, 17, v228
    v_cmp_eq_u32 s[88:89], 0, v228
    s_nop 1
    v_cndmask_b32 v243, v223, v227, s[88:89]
    v_subrev_u32 v228, 26, v222
    v_and_b32 v228, 17, v228
    v_cmp_eq_u32 s[88:89], 0, v228
    s_nop 1
    v_cndmask_b32 v244, v223, v227, s[88:89]
    v_subrev_u32 v228, 27, v222
    v_and_b32 v228, 17, v228
    v_cmp_eq_u32 s[88:89], 0, v228
    s_nop 1
    v_cndmask_b32 v245, v223, v227, s[88:89]
    s_waitcnt lgkmcnt(0)
    s_mul_i32 s12, s5, 7864320
    s_add_u32 s12, s48, s12
    s_addc_u32 s13, s49, 0
    s_mov_b32 s16, s12
    s_and_b32 s17, s13, 0xffff
    s_mov_b32 s18, 7864320
    s_mov_b32 s19, 0x20000
    s_add_u32 s94, s48, 25165824
    s_addc_u32 s95, s49, 0
    s_mov_b32 s96, s94
    s_and_b32 s97, s95, 0xffff
    s_mov_b32 s98, 262144
    s_mov_b32 s99, 0x20000
    v_and_b32 v2, 15, v1
    v_lshrrev_b32 v3, 4, v1
    s_lshl_b32 s12, s6, 3
    s_lshl_b32 s13, s28, 1
    s_add_u32 s12, s12, s13
    v_mul_u32_u24 v252, 21504, v3
    v_mul_u32_u24 v3, 128, v3
    v_add_u32 v3, s12, v3
    v_mul_u32_u24 v4, 640, v3
    v_lshl_add_u32 v4, v2, 4, v4
    v_mov_b32 v7, 1051011932
    v_mov_b32 v6, v7
    s_mul_i32 s13, s7, 12
    s_mul_i32 s12, s28, 1536
    s_add_u32 s12, s12, 50176
    v_add_u32 v252, s12, v252
    v_lshrrev_b32 v3, 2, v2
    v_mul_u32_u24 v3, 192, v3
    v_and_b32 v253, 3, v2
    v_lshl_add_u32 v3, v253, 4, v3
    v_add_u32 v253, v252, v3
    v_lshl_add_u32 v252, v2, 4, v252
    v_mov_b32 v2, 0
    v_mov_b32 v3, 0
    s_mov_b32 s25, 0
    s_mov_b32 s51, 0
    s_branch P1_cloop
    .p2align 10
P1_cloop:
    s_barrier
    s_waitcnt lgkmcnt(6)
    v_mfma_f32_16x16x32_bf16 v[88:91], v[148:151], v[176:179], v[88:91]
    ds_read_b128 v[168:171], v188 offset:0
    ds_read_b64_tr_b16 v[128:129], v187 offset:0
    v_mfma_f32_16x16x32_bf16 v[92:95], v[148:151], v[180:183], v[92:95]
    ds_read_b128 v[172:175], v188 offset:2048
    ds_read_b64_tr_b16 v[130:131], v187 offset:512
    v_mfma_f32_16x16x32_bf16 v[96:99], v[152:155], v[176:179], v[96:99]
    ds_read_b64_tr_b16 v[132:133], v187 offset:8
    v_mfma_f32_16x16x32_bf16 v[100:103], v[152:155], v[180:183], v[100:103]
    ds_read_b64_tr_b16 v[134:135], v187 offset:520
    s_waitcnt lgkmcnt(8)
    v_mfma_f32_16x16x32_bf16 v[104:107], v[156:159], v[176:179], v[104:107]
    ds_read_b64_tr_b16 v[136:137], v187 offset:16
    v_mfma_f32_16x16x32_bf16 v[108:111], v[156:159], v[180:183], v[108:111]
    ds_read_b64_tr_b16 v[138:139], v187 offset:528
    v_mfma_f32_16x16x32_bf16 v[112:115], v[160:163], v[176:179], v[112:115]
    ds_read_b64_tr_b16 v[140:141], v187 offset:24
    v_mfma_f32_16x16x32_bf16 v[116:119], v[160:163], v[180:183], v[116:119]
    ds_read_b64_tr_b16 v[142:143], v187 offset:536
    s_waitcnt lgkmcnt(6)
    v_mfma_f32_16x16x32_bf16 v[120:123], v[164:167], v[176:179], v[120:123]
    ds_read_b64_tr_b16 v[144:145], v187 offset:32
    v_mfma_f32_16x16x32_bf16 v[124:127], v[164:167], v[180:183], v[124:127]
    ds_read_b64_tr_b16 v[146:147], v187 offset:544
    v_mfma_f32_16x16x32_bf16 v[8:11], v[128:131], v[168:171], v[8:11]
    ds_read_b64_tr_b16 v[148:149], v187 offset:160
    v_mfma_f32_16x16x32_bf16 v[12:15], v[128:131], v[172:175], v[12:15]
    ds_read_b64_tr_b16 v[150:151], v187 offset:672
    s_waitcnt lgkmcnt(6)
    v_mfma_f32_16x16x32_bf16 v[16:19], v[132:135], v[168:171], v[16:19]
    ds_read_b64_tr_b16 v[152:153], v187 offset:168
    v_mfma_f32_16x16x32_bf16 v[20:23], v[132:135], v[172:175], v[20:23]
    ds_read_b64_tr_b16 v[154:155], v187 offset:680
    v_mfma_f32_16x16x32_bf16 v[24:27], v[136:139], v[168:171], v[24:27]
    ds_read_b128 v[176:179], v189 offset:0
    ds_read_b64_tr_b16 v[156:157], v187 offset:176
    v_mfma_f32_16x16x32_bf16 v[28:31], v[136:139], v[172:175], v[28:31]
    ds_read_b128 v[180:183], v189 offset:2048
    ds_read_b64_tr_b16 v[158:159], v187 offset:688
    s_waitcnt lgkmcnt(8)
    v_mfma_f32_16x16x32_bf16 v[32:35], v[140:143], v[168:171], v[32:35]
    ds_read_b64_tr_b16 v[160:161], v187 offset:184
    v_mfma_f32_16x16x32_bf16 v[36:39], v[140:143], v[172:175], v[36:39]
    ds_read_b64_tr_b16 v[162:163], v187 offset:696
    v_mfma_f32_16x16x32_bf16 v[40:43], v[144:147], v[168:171], v[40:43]
    ds_read_b64_tr_b16 v[164:165], v187 offset:192
    v_mfma_f32_16x16x32_bf16 v[44:47], v[144:147], v[172:175], v[44:47]
    ds_read_b64_tr_b16 v[166:167], v187 offset:704
    s_waitcnt lgkmcnt(8)
    v_mfma_f32_16x16x32_bf16 v[48:51], v[148:151], v[168:171], v[48:51]
    ds_read_b64_tr_b16 v[128:129], v187 offset:320
    v_mfma_f32_16x16x32_bf16 v[52:55], v[148:151], v[172:175], v[52:55]
    ds_read_b64_tr_b16 v[130:131], v187 offset:832
    v_mfma_f32_16x16x32_bf16 v[56:59], v[152:155], v[168:171], v[56:59]
    ds_read_b64_tr_b16 v[132:133], v187 offset:328
    v_mfma_f32_16x16x32_bf16 v[60:63], v[152:155], v[172:175], v[60:63]
    ds_read_b64_tr_b16 v[134:135], v187 offset:840
    s_waitcnt lgkmcnt(6)
    v_mfma_f32_16x16x32_bf16 v[64:67], v[156:159], v[168:171], v[64:67]
    ds_read_b64_tr_b16 v[136:137], v187 offset:336
    v_mfma_f32_16x16x32_bf16 v[68:71], v[156:159], v[172:175], v[68:71]
    ds_read_b64_tr_b16 v[138:139], v187 offset:848
    v_mfma_f32_16x16x32_bf16 v[72:75], v[160:163], v[168:171], v[72:75]
    ds_read_b64_tr_b16 v[140:141], v187 offset:344
    v_mfma_f32_16x16x32_bf16 v[76:79], v[160:163], v[172:175], v[76:79]
    ds_read_b64_tr_b16 v[142:143], v187 offset:856
    s_waitcnt lgkmcnt(6)
    v_mfma_f32_16x16x32_bf16 v[80:83], v[164:167], v[168:171], v[80:83]
    ds_read_b64_tr_b16 v[144:145], v187 offset:352
    v_mfma_f32_16x16x32_bf16 v[84:87], v[164:167], v[172:175], v[84:87]
    ds_read_b64_tr_b16 v[146:147], v187 offset:864
    v_mfma_f32_16x16x32_bf16 v[88:91], v[128:131], v[168:171], v[88:91]
    ds_read_b64_tr_b16 v[148:149], v187 offset:16896
    v_mfma_f32_16x16x32_bf16 v[92:95], v[128:131], v[172:175], v[92:95]
    ds_read_b64_tr_b16 v[150:151], v187 offset:17408
    s_waitcnt lgkmcnt(6)
    v_mfma_f32_16x16x32_bf16 v[96:99], v[132:135], v[168:171], v[96:99]
    ds_read_b64_tr_b16 v[152:153], v187 offset:16904
    v_mfma_f32_16x16x32_bf16 v[100:103], v[132:135], v[172:175], v[100:103]
    ds_read_b64_tr_b16 v[154:155], v187 offset:17416
    v_mfma_f32_16x16x32_bf16 v[104:107], v[136:139], v[168:171], v[104:107]
    ds_read_b64_tr_b16 v[156:157], v187 offset:16912
    v_mfma_f32_16x16x32_bf16 v[108:111], v[136:139], v[172:175], v[108:111]
    ds_read_b64_tr_b16 v[158:159], v187 offset:17424
    s_waitcnt lgkmcnt(6)
    v_mfma_f32_16x16x32_bf16 v[112:115], v[140:143], v[168:171], v[112:115]
    ds_read_b64_tr_b16 v[160:161], v187 offset:16920
    v_mfma_f32_16x16x32_bf16 v[116:119], v[140:143], v[172:175], v[116:119]
    ds_read_b64_tr_b16 v[162:163], v187 offset:17432
    v_mfma_f32_16x16x32_bf16 v[120:123], v[144:147], v[168:171], v[120:123]
    ds_read_b64_tr_b16 v[164:165], v187 offset:16928
    v_mfma_f32_16x16x32_bf16 v[124:127], v[144:147], v[172:175], v[124:127]
    ds_read_b64_tr_b16 v[166:167], v187 offset:17440
    s_waitcnt lgkmcnt(6)
    v_mfma_f32_16x16x32_bf16 v[8:11], v[148:151], v[176:179], v[8:11]
    ds_read_b64_tr_b16 v[128:129], v187 offset:17056
    v_mfma_f32_16x16x32_bf16 v[12:15], v[148:151], v[180:183], v[12:15]
    ds_read_b64_tr_b16 v[130:131], v187 offset:17568
    v_mfma_f32_16x16x32_bf16 v[16:19], v[152:155], v[176:179], v[16:19]
    ds_read_b64_tr_b16 v[132:133], v187 offset:17064
    v_mfma_f32_16x16x32_bf16 v[20:23], v[152:155], v[180:183], v[20:23]
    ds_read_b64_tr_b16 v[134:135], v187 offset:17576
    s_waitcnt lgkmcnt(6)
    v_mfma_f32_16x16x32_bf16 v[24:27], v[156:159], v[176:179], v[24:27]
    ds_read_b64_tr_b16 v[136:137], v187 offset:17072
    v_mfma_f32_16x16x32_bf16 v[28:31], v[156:159], v[180:183], v[28:31]
    ds_read_b64_tr_b16 v[138:139], v187 offset:17584
    v_mfma_f32_16x16x32_bf16 v[32:35], v[160:163], v[176:179], v[32:35]
    ds_read_b64_tr_b16 v[140:141], v187 offset:17080
    v_mfma_f32_16x16x32_bf16 v[36:39], v[160:163], v[180:183], v[36:39]
    ds_read_b64_tr_b16 v[142:143], v187 offset:17592
    s_waitcnt lgkmcnt(6)
    v_mfma_f32_16x16x32_bf16 v[40:43], v[164:167], v[176:179], v[40:43]
    ds_read_b64_tr_b16 v[144:145], v187 offset:17088
    v_mfma_f32_16x16x32_bf16 v[44:47], v[164:167], v[180:183], v[44:47]
    ds_read_b64_tr_b16 v[146:147], v187 offset:17600
    v_mfma_f32_16x16x32_bf16 v[48:51], v[128:131], v[176:179], v[48:51]
    ds_read_b64_tr_b16 v[148:149], v187 offset:17216
    v_mfma_f32_16x16x32_bf16 v[52:55], v[128:131], v[180:183], v[52:55]
    ds_read_b64_tr_b16 v[150:151], v187 offset:17728
    s_waitcnt lgkmcnt(6)
    v_mfma_f32_16x16x32_bf16 v[56:59], v[132:135], v[176:179], v[56:59]
    ds_read_b64_tr_b16 v[152:153], v187 offset:17224
    s_add_u32 s25, s25, 50176
    s_cmp_eq_u32 s25, 150528
    s_cselect_b32 s25, 0, s25
    v_mfma_f32_16x16x32_bf16 v[60:63], v[132:135], v[180:183], v[60:63]
    ds_read_b64_tr_b16 v[154:155], v187 offset:17736
    v_mfma_f32_16x16x32_bf16 v[64:67], v[136:139], v[176:179], v[64:67]
    ds_read_b64_tr_b16 v[156:157], v187 offset:17232
    v_add_u32 v188, s25, v185
    v_mfma_f32_16x16x32_bf16 v[68:71], v[136:139], v[180:183], v[68:71]
    ds_read_b64_tr_b16 v[158:159], v187 offset:17744
    s_waitcnt lgkmcnt(6)
    v_mfma_f32_16x16x32_bf16 v[72:75], v[140:143], v[176:179], v[72:75]
    ds_read_b64_tr_b16 v[160:161], v187 offset:17240
    v_add_u32 v189, s25, v186
    v_mfma_f32_16x16x32_bf16 v[76:79], v[140:143], v[180:183], v[76:79]
    ds_read_b64_tr_b16 v[162:163], v187 offset:17752
    s_add_u32 s51, s51, 1
    s_cmp_lt_u32 s51, 10
    v_mfma_f32_16x16x32_bf16 v[80:83], v[144:147], v[176:179], v[80:83]
    ds_read_b64_tr_b16 v[164:165], v187 offset:17248
    v_mfma_f32_16x16x32_bf16 v[84:87], v[144:147], v[180:183], v[84:87]
    ds_read_b64_tr_b16 v[166:167], v187 offset:17760
    v_add_u32 v187, s25, v184
    s_cbranch_scc1 P1_cloop
    s_waitcnt lgkmcnt(8)
    v_mfma_f32_16x16x32_bf16 v[88:91], v[148:151], v[176:179], v[88:91]
    v_mfma_f32_16x16x32_bf16 v[92:95], v[148:151], v[180:183], v[92:95]
    s_waitcnt lgkmcnt(6)
    v_mfma_f32_16x16x32_bf16 v[96:99], v[152:155], v[176:179], v[96:99]
    v_mfma_f32_16x16x32_bf16 v[100:103], v[152:155], v[180:183], v[100:103]
    s_waitcnt lgkmcnt(4)
    v_mfma_f32_16x16x32_bf16 v[104:107], v[156:159], v[176:179], v[104:107]
    v_mfma_f32_16x16x32_bf16 v[108:111], v[156:159], v[180:183], v[108:111]
    s_waitcnt lgkmcnt(2)
    v_mfma_f32_16x16x32_bf16 v[112:115], v[160:163], v[176:179], v[112:115]
    v_mfma_f32_16x16x32_bf16 v[116:119], v[160:163], v[180:183], v[116:119]
    s_waitcnt lgkmcnt(0)
    v_mfma_f32_16x16x32_bf16 v[120:123], v[164:167], v[176:179], v[120:123]
    v_mfma_f32_16x16x32_bf16 v[124:127], v[164:167], v[180:183], v[124:127]
    s_cmp_eq_u32 s5, 0
    s_cbranch_scc1 P1_epiA
    s_add_u32 s14, s13, 0
    s_mul_i32 s20, s14, 81920
    s_cmp_ge_u32 s14, 32
    s_cbranch_scc1 P1_ns0
    v_pk_mul_f32 v[8:9], v[6:7], v[8:9]
    v_pk_mul_f32 v[10:11], v[6:7], v[10:11]
    v_pk_mul_f32 v[12:13], v[6:7], v[12:13]
    v_pk_mul_f32 v[14:15], v[6:7], v[14:15]
    v_pk_mul_f32 v[16:17], v[6:7], v[16:17]
    v_pk_mul_f32 v[18:19], v[6:7], v[18:19]
    v_pk_mul_f32 v[20:21], v[6:7], v[20:21]
    v_pk_mul_f32 v[22:23], v[6:7], v[22:23]
    v_pk_mul_f32 v[24:25], v[6:7], v[24:25]
    v_pk_mul_f32 v[26:27], v[6:7], v[26:27]
    v_pk_mul_f32 v[28:29], v[6:7], v[28:29]
    v_pk_mul_f32 v[30:31], v[6:7], v[30:31]
    v_pk_mul_f32 v[32:33], v[6:7], v[32:33]
    v_pk_mul_f32 v[34:35], v[6:7], v[34:35]
    v_pk_mul_f32 v[36:37], v[6:7], v[36:37]
    v_pk_mul_f32 v[38:39], v[6:7], v[38:39]
    v_pk_mul_f32 v[40:41], v[6:7], v[40:41]
    v_pk_mul_f32 v[42:43], v[6:7], v[42:43]
    v_pk_mul_f32 v[44:45], v[6:7], v[44:45]
    v_pk_mul_f32 v[46:47], v[6:7], v[46:47]
P1_ns0:
    v_cvt_pk_bf16_f32 v128, v8, v9
    v_cvt_pk_bf16_f32 v129, v10, v11
    v_cvt_pk_bf16_f32 v130, v16, v17
    v_cvt_pk_bf16_f32 v131, v18, v19
    v_cvt_pk_bf16_f32 v132, v24, v25
    v_cvt_pk_bf16_f32 v133, v26, v27
    v_cvt_pk_bf16_f32 v134, v32, v33
    v_cvt_pk_bf16_f32 v135, v34, v35
    v_cvt_pk_bf16_f32 v136, v40, v41
    v_cvt_pk_bf16_f32 v137, v42, v43
    v_cvt_pk_bf16_f32 v140, v12, v13
    v_cvt_pk_bf16_f32 v141, v14, v15
    v_cvt_pk_bf16_f32 v142, v20, v21
    v_cvt_pk_bf16_f32 v143, v22, v23
    v_cvt_pk_bf16_f32 v144, v28, v29
    v_cvt_pk_bf16_f32 v145, v30, v31
    v_cvt_pk_bf16_f32 v146, v36, v37
    v_cvt_pk_bf16_f32 v147, v38, v39
    v_cvt_pk_bf16_f32 v148, v44, v45
    v_cvt_pk_bf16_f32 v149, v46, v47
    v_mov_b32 v138, v148
    v_mov_b32 v139, v149
    buffer_store_dwordx4 v[128:131], v4, s[16:19], s20 offen offset:0 sc1
    buffer_store_dwordx4 v[132:135], v4, s[16:19], s20 offen offset:256 sc1
    buffer_store_dwordx4 v[140:143], v4, s[16:19], s20 offen offset:768 sc1
    buffer_store_dwordx4 v[144:147], v4, s[16:19], s20 offen offset:1024 sc1
    buffer_store_dwordx4 v[136:139], v4, s[16:19], s20 offen offset:512 sc1
    s_add_u32 s14, s13, 4
    s_mul_i32 s20, s14, 81920
    s_cmp_ge_u32 s14, 32
    s_cbranch_scc1 P1_ns1
    v_pk_mul_f32 v[48:49], v[6:7], v[48:49]
    v_pk_mul_f32 v[50:51], v[6:7], v[50:51]
    v_pk_mul_f32 v[52:53], v[6:7], v[52:53]
    v_pk_mul_f32 v[54:55], v[6:7], v[54:55]
    v_pk_mul_f32 v[56:57], v[6:7], v[56:57]
    v_pk_mul_f32 v[58:59], v[6:7], v[58:59]
    v_pk_mul_f32 v[60:61], v[6:7], v[60:61]
    v_pk_mul_f32 v[62:63], v[6:7], v[62:63]
    v_pk_mul_f32 v[64:65], v[6:7], v[64:65]
    v_pk_mul_f32 v[66:67], v[6:7], v[66:67]
    v_pk_mul_f32 v[68:69], v[6:7], v[68:69]
    v_pk_mul_f32 v[70:71], v[6:7], v[70:71]
    v_pk_mul_f32 v[72:73], v[6:7], v[72:73]
    v_pk_mul_f32 v[74:75], v[6:7], v[74:75]
    v_pk_mul_f32 v[76:77], v[6:7], v[76:77]
    v_pk_mul_f32 v[78:79], v[6:7], v[78:79]
    v_pk_mul_f32 v[80:81], v[6:7], v[80:81]
    v_pk_mul_f32 v[82:83], v[6:7], v[82:83]
    v_pk_mul_f32 v[84:85], v[6:7], v[84:85]
    v_pk_mul_f32 v[86:87], v[6:7], v[86:87]
P1_ns1:
    v_cvt_pk_bf16_f32 v190, v48, v49
    v_cvt_pk_bf16_f32 v191, v50, v51
    v_cvt_pk_bf16_f32 v192, v56, v57
    v_cvt_pk_bf16_f32 v193, v58, v59
    v_cvt_pk_bf16_f32 v194, v64, v65
    v_cvt_pk_bf16_f32 v195, v66, v67
    v_cvt_pk_bf16_f32 v196, v72, v73
    v_cvt_pk_bf16_f32 v197, v74, v75
    v_cvt_pk_bf16_f32 v198, v80, v81
    v_cvt_pk_bf16_f32 v199, v82, v83
    v_cvt_pk_bf16_f32 v202, v52, v53
    v_cvt_pk_bf16_f32 v203, v54, v55
    v_cvt_pk_bf16_f32 v204, v60, v61
    v_cvt_pk_bf16_f32 v205, v62, v63
    v_cvt_pk_bf16_f32 v206, v68, v69
    v_cvt_pk_bf16_f32 v207, v70, v71
    v_cvt_pk_bf16_f32 v208, v76, v77
    v_cvt_pk_bf16_f32 v209, v78, v79
    v_cvt_pk_bf16_f32 v210, v84, v85
    v_cvt_pk_bf16_f32 v211, v86, v87
    v_mov_b32 v200, v210
    v_mov_b32 v201, v211
    buffer_store_dwordx4 v[190:193], v4, s[16:19], s20 offen offset:0 sc1
    buffer_store_dwordx4 v[194:197], v4, s[16:19], s20 offen offset:256 sc1
    buffer_store_dwordx4 v[202:205], v4, s[16:19], s20 offen offset:768 sc1
    buffer_store_dwordx4 v[206:209], v4, s[16:19], s20 offen offset:1024 sc1
    buffer_store_dwordx4 v[198:201], v4, s[16:19], s20 offen offset:512 sc1
    s_add_u32 s14, s13, 8
    s_mul_i32 s20, s14, 81920
    s_cmp_ge_u32 s14, 32
    s_cbranch_scc1 P1_ns2
    v_pk_mul_f32 v[88:89], v[6:7], v[88:89]
    v_pk_mul_f32 v[90:91], v[6:7], v[90:91]
    v_pk_mul_f32 v[92:93], v[6:7], v[92:93]
    v_pk_mul_f32 v[94:95], v[6:7], v[94:95]
    v_pk_mul_f32 v[96:97], v[6:7], v[96:97]
    v_pk_mul_f32 v[98:99], v[6:7], v[98:99]
    v_pk_mul_f32 v[100:101], v[6:7], v[100:101]
    v_pk_mul_f32 v[102:103], v[6:7], v[102:103]
    v_pk_mul_f32 v[104:105], v[6:7], v[104:105]
    v_pk_mul_f32 v[106:107], v[6:7], v[106:107]
    v_pk_mul_f32 v[108:109], v[6:7], v[108:109]
    v_pk_mul_f32 v[110:111], v[6:7], v[110:111]
    v_pk_mul_f32 v[112:113], v[6:7], v[112:113]
    v_pk_mul_f32 v[114:115], v[6:7], v[114:115]
    v_pk_mul_f32 v[116:117], v[6:7], v[116:117]
    v_pk_mul_f32 v[118:119], v[6:7], v[118:119]
    v_pk_mul_f32 v[120:121], v[6:7], v[120:121]
    v_pk_mul_f32 v[122:123], v[6:7], v[122:123]
    v_pk_mul_f32 v[124:125], v[6:7], v[124:125]
    v_pk_mul_f32 v[126:127], v[6:7], v[126:127]
P1_ns2:
    v_cvt_pk_bf16_f32 v152, v88, v89
    v_cvt_pk_bf16_f32 v153, v90, v91
    v_cvt_pk_bf16_f32 v154, v96, v97
    v_cvt_pk_bf16_f32 v155, v98, v99
    v_cvt_pk_bf16_f32 v156, v104, v105
    v_cvt_pk_bf16_f32 v157, v106, v107
    v_cvt_pk_bf16_f32 v158, v112, v113
    v_cvt_pk_bf16_f32 v159, v114, v115
    v_cvt_pk_bf16_f32 v160, v120, v121
    v_cvt_pk_bf16_f32 v161, v122, v123
    v_cvt_pk_bf16_f32 v164, v92, v93
    v_cvt_pk_bf16_f32 v165, v94, v95
    v_cvt_pk_bf16_f32 v166, v100, v101
    v_cvt_pk_bf16_f32 v167, v102, v103
    v_cvt_pk_bf16_f32 v168, v108, v109
    v_cvt_pk_bf16_f32 v169, v110, v111
    v_cvt_pk_bf16_f32 v170, v116, v117
    v_cvt_pk_bf16_f32 v171, v118, v119
    v_cvt_pk_bf16_f32 v172, v124, v125
    v_cvt_pk_bf16_f32 v173, v126, v127
    v_mov_b32 v162, v172
    v_mov_b32 v163, v173
    buffer_store_dwordx4 v[152:155], v4, s[16:19], s20 offen offset:0 sc1
    buffer_store_dwordx4 v[156:159], v4, s[16:19], s20 offen offset:256 sc1
    buffer_store_dwordx4 v[164:167], v4, s[16:19], s20 offen offset:768 sc1
    buffer_store_dwordx4 v[168:171], v4, s[16:19], s20 offen offset:1024 sc1
    buffer_store_dwordx4 v[160:163], v4, s[16:19], s20 offen offset:512 sc1
    s_waitcnt vmcnt(0)
    s_barrier
    v_mov_b32 v252, 140000
    s_nop 0
    ds_read_b64 v[250:251], v252
    s_waitcnt lgkmcnt(0)
    v_readfirstlane_b32 s0, v250
    v_readfirstlane_b32 s1, v251
    s_branch P2_cd
P1_epiA:
    s_nop 3
    v_cvt_pk_bf16_f32 v190, v48, v49
    v_cvt_pk_bf16_f32 v191, v50, v51
    v_cvt_pk_bf16_f32 v192, v56, v57
    v_cvt_pk_bf16_f32 v193, v58, v59
    v_cvt_pk_bf16_f32 v194, v64, v65
    v_cvt_pk_bf16_f32 v195, v66, v67
    v_cvt_pk_bf16_f32 v196, v72, v73
    v_cvt_pk_bf16_f32 v197, v74, v75
    v_cvt_pk_bf16_f32 v198, v80, v81
    v_cvt_pk_bf16_f32 v199, v82, v83
    v_cvt_pk_bf16_f32 v202, v52, v53
    v_cvt_pk_bf16_f32 v203, v54, v55
    v_cvt_pk_bf16_f32 v204, v60, v61
    v_cvt_pk_bf16_f32 v205, v62, v63
    v_cvt_pk_bf16_f32 v206, v68, v69
    v_cvt_pk_bf16_f32 v207, v70, v71
    v_cvt_pk_bf16_f32 v208, v76, v77
    v_cvt_pk_bf16_f32 v209, v78, v79
    v_cvt_pk_bf16_f32 v210, v84, v85
    v_cvt_pk_bf16_f32 v211, v86, v87
    v_cvt_pk_bf16_f32 v152, v88, v89
    v_cvt_pk_bf16_f32 v153, v90, v91
    v_cvt_pk_bf16_f32 v154, v96, v97
    v_cvt_pk_bf16_f32 v155, v98, v99
    v_cvt_pk_bf16_f32 v156, v104, v105
    v_cvt_pk_bf16_f32 v157, v106, v107
    v_cvt_pk_bf16_f32 v158, v112, v113
    v_cvt_pk_bf16_f32 v159, v114, v115
    v_cvt_pk_bf16_f32 v160, v120, v121
    v_cvt_pk_bf16_f32 v161, v122, v123
    v_cvt_pk_bf16_f32 v164, v92, v93
    v_cvt_pk_bf16_f32 v165, v94, v95
    v_cvt_pk_bf16_f32 v166, v100, v101
    v_cvt_pk_bf16_f32 v167, v102, v103
    v_cvt_pk_bf16_f32 v168, v108, v109
    v_cvt_pk_bf16_f32 v169, v110, v111
    v_cvt_pk_bf16_f32 v170, v116, v117
    v_cvt_pk_bf16_f32 v171, v118, v119
    v_cvt_pk_bf16_f32 v172, v124, v125
    v_cvt_pk_bf16_f32 v173, v126, v127
    s_cmp_lg_u32 s28, 3
    s_cbranch_scc1 P1_nh
    s_lshl_b32 s14, s7, 2
    s_mul_i32 s20, s14, 81920
    s_add_u32 s20, s20, 2621440
    s_mul_i32 s21, s14, 81920
    s_add_u32 s21, s21, 5242880
    v_mov_b32 v200, v210
    v_mov_b32 v201, v211
    buffer_store_dwordx4 v[190:193], v4, s[16:19], s20 offen offset:0 sc1
    buffer_store_dwordx4 v[194:197], v4, s[16:19], s20 offen offset:256 sc1
    buffer_store_dwordx4 v[202:205], v4, s[16:19], s20 offen offset:768 sc1
    buffer_store_dwordx4 v[206:209], v4, s[16:19], s20 offen offset:1024 sc1
    buffer_store_dwordx4 v[198:201], v4, s[16:19], s20 offen offset:512 sc1
    v_mov_b32 v162, v172
    v_mov_b32 v163, v173
    buffer_store_dwordx4 v[152:155], v4, s[16:19], s21 offen offset:0 sc1
    buffer_store_dwordx4 v[156:159], v4, s[16:19], s21 offen offset:256 sc1
    buffer_store_dwordx4 v[164:167], v4, s[16:19], s21 offen offset:768 sc1
    buffer_store_dwordx4 v[168:171], v4, s[16:19], s21 offen offset:1024 sc1
    buffer_store_dwordx4 v[160:163], v4, s[16:19], s21 offen offset:512 sc1
    s_nop 1
P1_nh:
    v_mov_b32 v162, 0x3f803f80
    v_mov_b32 v163, 0x3f803f80
    v_mov_b32 v174, 0x3f803f80
    v_mov_b32 v175, 0x3f803f80
    ds_write_b128 v252, v[190:193] offset:1536
    ds_write_b128 v252, v[194:197] offset:2048
    ds_write_b64 v252, v[198:199] offset:2568
    ds_write_b64 v252, v[2:3] offset:2560
    ds_write_b128 v252, v[202:205] offset:1792
    ds_write_b128 v252, v[206:209] offset:2304
    ds_write_b64 v252, v[210:211] offset:2824
    ds_write_b64 v252, v[2:3] offset:2816
    ds_write_b128 v253, v[152:155] offset:15360
    ds_write_b128 v253, v[156:159] offset:15424
    ds_write_b128 v253, v[160:163] offset:15488
    ds_write_b128 v253, v[164:167] offset:16128
    ds_write_b128 v253, v[168:171] offset:16192
    ds_write_b128 v253, v[172:175] offset:16256
    v_pk_mul_f32 v[8:9], v[6:7], v[8:9]
    v_pk_mul_f32 v[10:11], v[6:7], v[10:11]
    v_pk_mul_f32 v[12:13], v[6:7], v[12:13]
    v_pk_mul_f32 v[14:15], v[6:7], v[14:15]
    v_pk_mul_f32 v[16:17], v[6:7], v[16:17]
    v_pk_mul_f32 v[18:19], v[6:7], v[18:19]
    v_pk_mul_f32 v[20:21], v[6:7], v[20:21]
    v_pk_mul_f32 v[22:23], v[6:7], v[22:23]
    v_pk_mul_f32 v[24:25], v[6:7], v[24:25]
    v_pk_mul_f32 v[26:27], v[6:7], v[26:27]
    v_pk_mul_f32 v[28:29], v[6:7], v[28:29]
    v_pk_mul_f32 v[30:31], v[6:7], v[30:31]
    v_pk_mul_f32 v[32:33], v[6:7], v[32:33]
    v_pk_mul_f32 v[34:35], v[6:7], v[34:35]
    v_pk_mul_f32 v[36:37], v[6:7], v[36:37]
    v_pk_mul_f32 v[38:39], v[6:7], v[38:39]
    v_pk_mul_f32 v[40:41], v[6:7], v[40:41]
    v_pk_mul_f32 v[42:43], v[6:7], v[42:43]
    v_pk_mul_f32 v[44:45], v[6:7], v[44:45]
    v_pk_mul_f32 v[46:47], v[6:7], v[46:47]
    v_cvt_pk_bf16_f32 v128, v8, v9
    v_cvt_pk_bf16_f32 v129, v10, v11
    v_cvt_pk_bf16_f32 v130, v16, v17
    v_cvt_pk_bf16_f32 v131, v18, v19
    v_cvt_pk_bf16_f32 v132, v24, v25
    v_cvt_pk_bf16_f32 v133, v26, v27
    v_cvt_pk_bf16_f32 v134, v32, v33
    v_cvt_pk_bf16_f32 v135, v34, v35
    v_cvt_pk_bf16_f32 v136, v40, v41
    v_cvt_pk_bf16_f32 v137, v42, v43
    v_cvt_pk_bf16_f32 v140, v12, v13
    v_cvt_pk_bf16_f32 v141, v14, v15
    v_cvt_pk_bf16_f32 v142, v20, v21
    v_cvt_pk_bf16_f32 v143, v22, v23
    v_cvt_pk_bf16_f32 v144, v28, v29
    v_cvt_pk_bf16_f32 v145, v30, v31
    v_cvt_pk_bf16_f32 v146, v36, v37
    v_cvt_pk_bf16_f32 v147, v38, v39
    v_cvt_pk_bf16_f32 v148, v44, v45
    v_cvt_pk_bf16_f32 v149, v46, v47
    ds_write_b128 v252, v[128:131] offset:7680
    ds_write_b128 v252, v[132:135] offset:8192
    ds_write_b64 v252, v[136:137] offset:8712
    ds_write_b64 v252, v[2:3] offset:8704
    ds_write_b128 v252, v[140:143] offset:7936
    ds_write_b128 v252, v[144:147] offset:8448
    ds_write_b64 v252, v[148:149] offset:8968
    ds_write_b64 v252, v[2:3] offset:8960
    s_add_u32 s12, s48, 18874368
    s_addc_u32 s13, s49, 0
    s_mov_b32 s15, s28
    s_mov_b32 s16, 1
    s_mov_b32 s40, 25165824
    s_waitcnt lgkmcnt(0)
    s_barrier
    v_mov_b32 v252, 140000
    s_nop 0
    ds_read_b64 v[250:251], v252
    s_waitcnt lgkmcnt(0)
    v_readfirstlane_b32 s0, v250
    v_readfirstlane_b32 s1, v251
    s_cmp_lg_u32 s28, 3
    s_cbranch_scc1 P2_a_enter
    s_and_b32 s21, s6, 7
    s_cmp_eq_u32 s21, 7
    s_cselect_b32 s21, -54, 8
    s_add_u32 s21, s21, s2
    s_and_b32 s20, s21, 7
    s_lshl_b32 s20, s20, 2
    s_bfe_u32 s22, s21, 0x20003
    s_or_b32 s20, s20, s22
    s_andn2_b32 s21, s21, 31
    s_or_b32 s21, s21, s20
    s_lshl_b32 s21, s21, 9
    s_add_u32 s21, s21, 24
    s_cmp_lt_u32 s6, 15
    s_cselect_b32 s21, s21, 2147479552
    v_min_u32 v2, 3, v1
    v_lshlrev_b32 v2, 7, v2
    v_add_u32 v2, s21, v2
    s_waitcnt vmcnt(0)
    buffer_store_dwordx2 v[250:251], v2, s[96:99], 0 offen sc1
P2_a_enter:
    s_mov_b32 s24, s12
    s_and_b32 s25, s13, 0xffff
    s_mov_b32 s26, 5242880
    s_mov_b32 s27, 0x20000
    s_mul_i32 s14, s15, 21504
    s_add_u32 s14, s14, 50176
    s_lshl_b32 s12, s7, 2
    s_add_u32 s15, s15, s12
P2_a_unit:
    s_mul_i32 s12, s16, 1536
    s_add_u32 s12, s12, s14
    v_add_u32 v28, s12, v224
    s_add_u32 s13, s12, 13824
    v_add_u32 v29, s13, v225
    v_add_u32 v30, 7680, v28
    s_lshl_b32 s12, s6, 3
    s_lshl_b32 s13, s16, 1
    s_add_u32 s17, s12, s13
    s_or_b32 s87, s6, s16
P2_a_start:
    ds_read_b128 v[20:23], v30 offset:0
    ds_read_b128 v[24:27], v30 offset:1024
    ds_read_b128 v[160:163], v28 offset:0
    ds_read_b128 v[164:167], v28 offset:1024
    ds_read_b128 v[168:171], v28 offset:1536
    ds_read_b128 v[172:175], v28 offset:2560
    ds_read_b64_tr_b16 v[176:177], v29 offset:0
    ds_read_b64_tr_b16 v[178:179], v29 offset:384
    ds_read_b64_tr_b16 v[180:181], v29 offset:768
    ds_read_b64_tr_b16 v[182:183], v29 offset:1152
    ds_read_b64_tr_b16 v[184:185], v29 offset:1536
    ds_read_b64_tr_b16 v[186:187], v29 offset:1920
    ds_read_b64_tr_b16 v[188:189], v29 offset:2304
    ds_read_b64_tr_b16 v[190:191], v29 offset:2688
    s_lshr_b32 s88, s15, 3
    s_mul_i32 s88, s88, 5120
    s_mul_i32 s89, s17, 20480
    s_add_u32 s88, s88, s89
    s_and_b32 s89, s15, 7
    s_lshl_b32 s90, s89, 9
    s_add_u32 s90, s90, s88
    s_lshl_b32 s89, s89, 7
    s_add_u32 s89, s89, s88
    s_add_u32 s89, s89, 4096
    v_lshrrev_b32 v2, 5, v1
    v_lshl_add_u32 v2, v2, 8, v226
    v_add_u32 v32, s90, v2
    v_and_b32 v2, 15, v1
    v_lshlrev_b32 v2, 3, v2
    v_sub_u32 v3, v226, v2
    v_add_u32 v3, s89, v3
    v_cmp_gt_u32 vcc, 32, v1
    v_mov_b32 v2, 2147479552
    s_nop 0
    v_cndmask_b32 v33, v2, v3, vcc
    s_waitcnt lgkmcnt(12)
    v_mov_b32 v24, 0
    v_mov_b32 v25, 0
    s_mov_b32 s88, -1
    s_mov_b32 s89, 0
    v_mov_b32 v228, 0
    v_cndmask_b32 v26, v228, v26, s[88:89]
    v_cndmask_b32 v27, v228, v27, s[88:89]
    s_nop 0
    s_waitcnt lgkmcnt(10)
    v_mfma_f32_32x32x16_bf16 v[112:127], v[160:163], v[20:23], v[230:245]
    v_mfma_f32_32x32x16_bf16 v[112:127], v[164:167], v[24:27], v[112:127]
    s_waitcnt lgkmcnt(8)
    v_mfma_f32_32x32x16_bf16 v[128:143], v[168:171], v[20:23], v[230:245]
    v_mfma_f32_32x32x16_bf16 v[128:143], v[172:175], v[24:27], v[128:143]
    s_cmp_eq_u32 s87, 0
    s_nop 7
    s_cbranch_scc1 P2_a_inv
P2_a_val:
    s_nop 3
    v_cndmask_b32 v112, v112, v128, s[52:53]
    v_cndmask_b32 v113, v113, v129, s[54:55]
    v_cndmask_b32 v114, v114, v130, s[56:57]
    v_cndmask_b32 v115, v115, v131, s[58:59]
    v_cndmask_b32 v116, v116, v132, s[60:61]
    v_cndmask_b32 v117, v117, v133, s[62:63]
    v_cndmask_b32 v118, v118, v134, s[64:65]
    v_cndmask_b32 v119, v119, v135, s[66:67]
    v_cndmask_b32 v120, v120, v136, s[68:69]
    v_cndmask_b32 v121, v121, v137, s[70:71]
    v_cndmask_b32 v122, v122, v138, s[72:73]
    v_cndmask_b32 v123, v123, v139, s[74:75]
    v_cndmask_b32 v124, v124, v140, s[76:77]
    v_cndmask_b32 v125, v125, v141, s[78:79]
    v_cndmask_b32 v126, v126, v142, s[80:81]
    v_cndmask_b32 v127, v127, v143, s[82:83]
    s_cmp_eq_u32 s92, 1
    s_cbranch_scc1 P2_a_max
    v_exp_f32 v112, v112
    v_exp_f32 v113, v113
    v_exp_f32 v114, v114
    v_exp_f32 v115, v115
    v_exp_f32 v116, v116
    v_exp_f32 v117, v117
    v_exp_f32 v118, v118
    v_exp_f32 v119, v119
    v_exp_f32 v120, v120
    v_exp_f32 v121, v121
    v_exp_f32 v122, v122
    v_exp_f32 v123, v123
    v_exp_f32 v124, v124
    v_exp_f32 v125, v125
    v_exp_f32 v126, v126
    v_exp_f32 v127, v127
    s_nop 0
    v_cvt_pk_bf16_f32 v144, v112, v113
    v_cvt_pk_bf16_f32 v145, v114, v115
    v_cvt_pk_bf16_f32 v146, v116, v117
    v_cvt_pk_bf16_f32 v147, v118, v119
    v_cvt_pk_bf16_f32 v148, v120, v121
    v_cvt_pk_bf16_f32 v149, v122, v123
    v_cvt_pk_bf16_f32 v150, v124, v125
    v_cvt_pk_bf16_f32 v151, v126, v127
    v_and_b32 v152, v144, v214
    v_bfi_b32 v144, v214, 0, v144
    v_and_b32 v153, v145, v215
    v_bfi_b32 v145, v215, 0, v145
    v_and_b32 v154, v146, v216
    v_bfi_b32 v146, v216, 0, v146
    v_and_b32 v155, v147, v217
    v_bfi_b32 v147, v217, 0, v147
    v_and_b32 v156, v148, v218
    v_bfi_b32 v148, v218, 0, v148
    v_and_b32 v157, v149, v219
    v_bfi_b32 v149, v219, 0, v149
    v_and_b32 v158, v150, v220
    v_bfi_b32 v150, v220, 0, v150
    v_and_b32 v159, v151, v221
    v_bfi_b32 v151, v221, 0, v151
    s_waitcnt lgkmcnt(0)
    s_cmp_lg_u32 s16, 0
    s_cbranch_scc1 P2_a_np
    s_load_dwordx8 s[32:39], s[48:49], s40 glc
P2_a_np:
    v_mfma_f32_32x32x16_bf16 v[192:207], v[176:179], v[144:147], 0
    v_mfma_f32_32x32x16_bf16 v[192:207], v[180:183], v[148:151], v[192:207]
    v_mfma_f32_32x32x16_bf16 v[192:207], v[184:187], v[152:155], v[192:207]
    v_mfma_f32_32x32x16_bf16 v[192:207], v[188:191], v[156:159], v[192:207]
    s_nop 7
    s_nop 3
    v_rcp_f32 v228, v204
    v_add_f32 v229, |v192|, |v193|
    v_add_f32 v229, v229, |v194|
    v_add_f32 v229, v229, |v195|
    v_add_f32 v229, v229, |v196|
    v_add_f32 v229, v229, |v197|
    v_add_f32 v229, v229, |v198|
    v_add_f32 v229, v229, |v199|
    v_add_f32 v229, v229, |v200|
    v_add_f32 v229, v229, |v201|
    v_add_f32 v229, v229, |v202|
    v_add_f32 v229, v229, |v203|
    v_cmp_le_f32 s[88:89], s84, v204
    v_cmp_ge_f32 s[90:91], s85, v204
    v_cmp_gt_f32 vcc, -v223, v229
    v_mul_f32 v192, v192, v228
    v_mul_f32 v193, v193, v228
    v_mul_f32 v194, v194, v228
    v_mul_f32 v195, v195, v228
    v_mul_f32 v196, v196, v228
    v_mul_f32 v197, v197, v228
    v_mul_f32 v198, v198, v228
    v_mul_f32 v199, v199, v228
    v_mul_f32 v200, v200, v228
    v_mul_f32 v201, v201, v228
    v_mul_f32 v202, v202, v228
    v_mul_f32 v203, v203, v228
    s_and_b64 s[88:89], s[88:89], s[90:91]
    s_and_b64 s[88:89], s[88:89], vcc
    s_or_b32 s90, s92, 0
    s_cbranch_scc1 P2_a_ok
    s_cmp_eq_u64 s[88:89], exec
    s_cbranch_scc0 P2_a_fb
P2_a_ok:
    v_cvt_pk_bf16_f32 v192, v192, v193
    v_cvt_pk_bf16_f32 v193, v194, v195
    v_cvt_pk_bf16_f32 v194, v196, v197
    v_cvt_pk_bf16_f32 v195, v198, v199
    v_cvt_pk_bf16_f32 v196, v200, v201
    v_cvt_pk_bf16_f32 v197, v202, v203
    s_mov_b32 s88, 0
    v_permlane32_swap_b32 v192, v194
    v_permlane32_swap_b32 v193, v195
    buffer_store_dwordx2 v[196:197], v33, s[24:27], s88 offen sc1
    buffer_store_dwordx4 v[192:195], v32, s[24:27], s88 offen sc1
    s_cmp_lg_u32 s92, 0
    s_cbranch_scc1 P2_a_rst
P2_a_next:
    s_cmp_eq_u32 s16, 0
    s_cbranch_scc1 L_Aret
    s_add_u32 s16, s16, 1
    s_cmp_lt_u32 s16, 4
    s_cbranch_scc1 P2_a_unit
P2_cd:
    s_and_b32 s3, s2, 7
    s_lshl_b32 s3, s3, 2
    s_bfe_u32 s4, s2, 0x20003
    s_or_b32 s3, s3, s4
    s_lshr_b32 s4, s2, 5
    s_mov_b64 s[46:47], s[36:37]
    s_mov_b32 s12, 0x1999999a
    v_add_u32 v8, 0, v1
    v_mul_hi_u32 v9, v8, s12
    v_mul_u32_u24 v10, 10, v9
    v_sub_u32 v10, v8, v10
    v_bfe_u32 v11, v9, 2, 2
    v_lshlrev_b32 v11, 3, v11
    v_bfe_u32 v7, v9, 4, 1
    v_lshl_add_u32 v11, v7, 2, v11
    v_and_b32 v7, 3, v9
    v_add_u32 v11, v11, v7
    v_lshrrev_b32 v7, 4, v11
    v_lshl_add_u32 v7, v7, 2, v11
    v_mul_u32_u24 v7, 1280, v7
    v_lshl_add_u32 v36, v10, 4, v7
    v_lshrrev_b32 v7, 2, v11
    v_lshl_add_u32 v7, v7, 4, v11
    v_add_u32 v7, 16, v7
    v_mul_u32_u24 v7, 1280, v7
    v_lshl_add_u32 v41, v10, 4, v7
    v_add_u32 v8, 64, v1
    v_mul_hi_u32 v9, v8, s12
    v_mul_u32_u24 v10, 10, v9
    v_sub_u32 v10, v8, v10
    v_bfe_u32 v11, v9, 2, 2
    v_lshlrev_b32 v11, 3, v11
    v_bfe_u32 v7, v9, 4, 1
    v_lshl_add_u32 v11, v7, 2, v11
    v_and_b32 v7, 3, v9
    v_add_u32 v11, v11, v7
    v_lshrrev_b32 v7, 4, v11
    v_lshl_add_u32 v7, v7, 2, v11
    v_mul_u32_u24 v7, 1280, v7
    v_lshl_add_u32 v37, v10, 4, v7
    v_lshrrev_b32 v7, 2, v11
    v_lshl_add_u32 v7, v7, 4, v11
    v_add_u32 v7, 16, v7
    v_mul_u32_u24 v7, 1280, v7
    v_lshl_add_u32 v42, v10, 4, v7
    v_add_u32 v8, 128, v1
    v_mul_hi_u32 v9, v8, s12
    v_mul_u32_u24 v10, 10, v9
    v_sub_u32 v10, v8, v10
    v_bfe_u32 v11, v9, 2, 2
    v_lshlrev_b32 v11, 3, v11
    v_bfe_u32 v7, v9, 4, 1
    v_lshl_add_u32 v11, v7, 2, v11
    v_and_b32 v7, 3, v9
    v_add_u32 v11, v11, v7
    v_lshrrev_b32 v7, 4, v11
    v_lshl_add_u32 v7, v7, 2, v11
    v_mul_u32_u24 v7, 1280, v7
    v_lshl_add_u32 v38, v10, 4, v7
    v_lshrrev_b32 v7, 2, v11
    v_lshl_add_u32 v7, v7, 4, v11
    v_add_u32 v7, 16, v7
    v_mul_u32_u24 v7, 1280, v7
    v_lshl_add_u32 v43, v10, 4, v7
    v_add_u32 v8, 192, v1
    v_mul_hi_u32 v9, v8, s12
    v_mul_u32_u24 v10, 10, v9
    v_sub_u32 v10, v8, v10
    v_bfe_u32 v11, v9, 2, 2
    v_lshlrev_b32 v11, 3, v11
    v_bfe_u32 v7, v9, 4, 1
    v_lshl_add_u32 v11, v7, 2, v11
    v_and_b32 v7, 3, v9
    v_add_u32 v11, v11, v7
    v_lshrrev_b32 v7, 4, v11
    v_lshl_add_u32 v7, v7, 2, v11
    v_mul_u32_u24 v7, 1280, v7
    v_lshl_add_u32 v39, v10, 4, v7
    v_lshrrev_b32 v7, 2, v11
    v_lshl_add_u32 v7, v7, 4, v11
    v_add_u32 v7, 16, v7
    v_mul_u32_u24 v7, 1280, v7
    v_lshl_add_u32 v44, v10, 4, v7
    v_add_u32 v8, 256, v1
    v_mul_hi_u32 v9, v8, s12
    v_mul_u32_u24 v10, 10, v9
    v_sub_u32 v10, v8, v10
    v_bfe_u32 v11, v9, 2, 2
    v_lshlrev_b32 v11, 3, v11
    v_bfe_u32 v7, v9, 4, 1
    v_lshl_add_u32 v11, v7, 2, v11
    v_and_b32 v7, 3, v9
    v_add_u32 v11, v11, v7
    v_lshrrev_b32 v7, 4, v11
    v_lshl_add_u32 v7, v7, 2, v11
    v_mul_u32_u24 v7, 1280, v7
    v_lshl_add_u32 v40, v10, 4, v7
    v_lshrrev_b32 v7, 2, v11
    v_lshl_add_u32 v7, v7, 4, v11
    v_add_u32 v7, 16, v7
    v_mul_u32_u24 v7, 1280, v7
    v_lshl_add_u32 v45, v10, 4, v7
    s_and_b32 s12, s2, 3
    s_lshl_b32 s9, s12, 2
    s_bfe_u32 s12, s2, 0x20003
    s_add_u32 s9, s9, s12
    s_lshr_b32 s10, s2, 5
    s_mov_b32 s11, 2
    s_bfe_u32 s8, s2, 0x10002
    s_lshl_b32 s12, s9, 3
    s_add_u32 s12, s12, s10
    s_lshl_b32 s12, s12, 9
    s_add_u32 s12, s12, 131072
    s_cmp_eq_u32 s8, 0
    s_cselect_b32 s12, s12, 2147479552
    v_and_b32 v13, 7, v1
    v_lshlrev_b32 v13, 3, v13
    v_add_u32 v13, s12, v13
    v_and_b32 v12, 3, v1
    v_lshlrev_b32 v12, 3, v12
    s_lshl_b32 s12, s9, 3
    s_lshl_b32 s14, s28, 1
    s_add_u32 s12, s12, s14
    s_mul_i32 s15, s12, 20480
    s_mul_i32 s21, s8, 2621440
    s_add_u32 s15, s15, s21
    v_lshlrev_b32 v7, 4, v1
    v_add_u32 v7, s15, v7
    v_add_u32 v6, 20480, v7
    v_and_b32 v2, 15, v1
    v_lshlrev_b32 v2, 3, v2
    v_sub_u32 v11, v7, v2
    v_add_u32 v11, 4096, v11
    v_add_u32 v15, 20480, v11
    v_lshrrev_b32 v9, 2, v1
    v_mul_u32_u24 v9, 160, v9
    v_and_b32 v10, 3, v1
    v_lshlrev_b32 v10, 3, v10
    v_add_u32 v8, v9, v10
    v_add_u32 v8, 49152, v8
    v_add_u32 v9, 51200, v8
    v_and_b32 v2, 15, v1
    v_lshrrev_b32 v3, 4, v1
    s_lshl_b32 s12, s9, 7
    s_lshl_b32 s14, s28, 5
    s_add_u32 s12, s12, s14
    v_add_u32 v2, s12, v2
    v_mul_u32_u24 v2, 2560, v2
    s_mul_i32 s14, s8, 1280
    s_mul_i32 s20, s10, 160
    s_add_u32 s14, s14, s20
    v_add_u32 v2, s14, v2
    v_lshl_add_u32 v59, v3, 3, v2
    v_and_b32 v5, 1, v3
    v_lshl_add_u32 v2, v5, 5, v2
    v_lshrrev_b32 v5, 1, v3
    v_lshl_add_u32 v58, v5, 4, v2
    v_mov_b32 v19, 2147479552
    v_mov_b32 v53, v12
    s_cmp_eq_u32 s4, 0
    s_cselect_b64 s[88:89], exec, 0
    s_nop 1
    v_cndmask_b32 v80, v227, v223, s[88:89]
    v_cndmask_b32 v81, v227, v223, s[88:89]
    v_cndmask_b32 v82, v227, v223, s[88:89]
    v_cndmask_b32 v83, v227, v223, s[88:89]
    v_cndmask_b32 v84, v227, v223, s[88:89]
    v_cndmask_b32 v85, v227, v223, s[88:89]
    v_cndmask_b32 v86, v227, v223, s[88:89]
    v_cndmask_b32 v87, v227, v223, s[88:89]
    v_cndmask_b32 v88, v227, v223, s[88:89]
    v_cndmask_b32 v89, v227, v223, s[88:89]
    v_cndmask_b32 v90, v227, v223, s[88:89]
    v_cndmask_b32 v91, v227, v223, s[88:89]
    v_cndmask_b32 v92, v227, v223, s[88:89]
    v_cndmask_b32 v93, v227, v223, s[88:89]
    v_cndmask_b32 v94, v227, v223, s[88:89]
    v_cndmask_b32 v95, v227, v223, s[88:89]
P2_pre:
    s_lshl_b32 s12, s6, 9
    s_add_u32 s12, s12, s7
    s_lshl_b32 s12, s12, 3
    s_add_u32 s12, s12, 131072
    s_cmp_eq_u32 s5, 0
    s_cselect_b32 s12, s12, 2147479552
    s_cmp_eq_u32 s28, 4
    s_cselect_b32 s12, s12, 2147479552
    v_min_u32 v18, 7, v1
    v_lshlrev_b32 v18, 9, v18
    v_add_u32 v18, s12, v18
    s_bfe_u32 s5, s2, 0x10002
    s_add_u32 s12, s48, 18874368
    s_addc_u32 s13, s49, 0
    s_mov_b32 s24, s12
    s_and_b32 s25, s13, 0xffff
    s_mov_b32 s26, 5242880
    s_mov_b32 s27, 0x20000
    s_mul_i32 s12, s28, 1536
    s_add_u32 s13, s12, 0
    v_add_u32 v28, s13, v224
    s_add_u32 s13, s12, 151552
    v_add_u32 v30, s13, v224
    s_add_u32 s13, s12, 24576
    v_add_u32 v29, s13, v225
    s_sub_u32 s86, 8, s28
    s_cmp_eq_u32 s4, 0
    s_cselect_b32 s86, s86, -1
    s_lshl_b32 s12, s4, 4
    s_lshl_b32 s13, s28, 1
    s_add_u32 s17, s12, s13
    s_lshr_b32 s88, s3, 3
    s_mul_i32 s88, s88, 5120
    s_mul_i32 s89, s17, 20480
    s_add_u32 s88, s88, s89
    s_and_b32 s89, s3, 7
    s_lshl_b32 s90, s89, 9
    s_add_u32 s90, s90, s88
    s_lshl_b32 s89, s89, 7
    s_add_u32 s89, s89, s88
    s_add_u32 s89, s89, 4096
    v_lshrrev_b32 v2, 5, v1
    v_lshl_add_u32 v2, v2, 8, v226
    v_add_u32 v32, s90, v2
    v_and_b32 v2, 15, v1
    v_lshlrev_b32 v2, 3, v2
    v_sub_u32 v3, v226, v2
    v_add_u32 v3, s89, v3
    v_cmp_gt_u32 vcc, 32, v1
    v_mov_b32 v2, 2147479552
    s_nop 0
    v_cndmask_b32 v33, v2, v3, vcc
    s_and_b32 s12, s2, 3
    s_lshl_b32 s9, s12, 2
    s_bfe_u32 s12, s2, 0x20003
    s_add_u32 s9, s9, s12
    s_lshr_b32 s10, s2, 5
    s_mov_b32 s11, 2
    s_cmp_eq_u32 s5, 0
    s_cselect_b32 s16, s46, s42
    s_cselect_b32 s17, s47, s43
    s_and_b32 s17, s17, 0xffff
    s_mov_b32 s18, 819200
    s_mov_b32 s19, 0x20000
    s_mul_i32 s20, s10, 160
    .p2align 5
    s_nop 0
    s_nop 0
    s_nop 0
    s_nop 0
    s_cmp_lt_u32 s28, 4
    s_cbranch_scc1 P2_bd
    s_setprio 1
    s_waitcnt vmcnt(0)
    ds_write_b64 v53, v[54:55]
    ds_write_b64 v53, v[54:55] offset:3072
P2_bd:
    s_waitcnt vmcnt(0) lgkmcnt(0)
    s_barrier
    ds_read_b128 v[20:23], v30 offset:0
    ds_read_b128 v[24:27], v30 offset:1024
    ds_read_b128 v[160:163], v28 offset:0
    ds_read_b128 v[164:167], v28 offset:1024
    ds_read_b128 v[168:171], v28 offset:1536
    ds_read_b128 v[172:175], v28 offset:2560
    buffer_store_dwordx2 v[250:251], v18, s[96:99], 0 offen sc1
    s_waitcnt lgkmcnt(4)
    v_mov_b32 v24, 0
    v_mov_b32 v25, 0
    s_mov_b32 s88, -1
    s_mov_b32 s89, 0
    v_mov_b32 v228, 0
    v_cndmask_b32 v26, v228, v26, s[88:89]
    v_cndmask_b32 v27, v228, v27, s[88:89]
    s_nop 0
    s_branch P2_b_go
P2_b_start:
    ds_read_b128 v[160:163], v28 offset:0
    ds_read_b128 v[164:167], v28 offset:1024
    ds_read_b128 v[168:171], v28 offset:1536
    ds_read_b128 v[172:175], v28 offset:2560
P2_b_go:
    s_waitcnt lgkmcnt(2)
    v_mfma_f32_32x32x16_bf16 v[96:111], v[160:163], v[20:23], v[80:95]
    v_mfma_f32_32x32x16_bf16 v[96:111], v[164:167], v[24:27], v[96:111]
    ds_read_b128 v[160:163], v28 offset:3072
    ds_read_b128 v[164:167], v28 offset:4096
    s_cmp_lg_u32 s86, 1
    s_cbranch_scc1 P2_cb1
    s_nop 7
    v_mov_b32 v80, v227
    v_mov_b32 v81, v227
    v_mov_b32 v82, v227
    v_mov_b32 v83, v227
    v_mov_b32 v84, v227
    v_mov_b32 v85, v227
    v_mov_b32 v86, v227
    v_mov_b32 v87, v227
    v_mov_b32 v88, v227
    v_mov_b32 v89, v227
    v_mov_b32 v90, v227
    v_mov_b32 v91, v227
    v_mov_b32 v92, v227
    v_mov_b32 v93, v227
    v_mov_b32 v94, v227
    v_mov_b32 v95, v227
    s_nop 1
P2_cb1:
    s_waitcnt lgkmcnt(2)
    v_mfma_f32_32x32x16_bf16 v[112:127], v[168:171], v[20:23], v[80:95]
    v_mfma_f32_32x32x16_bf16 v[112:127], v[172:175], v[24:27], v[112:127]
    ds_read_b64_tr_b16 v[184:185], v29 offset:1536
    ds_read_b64_tr_b16 v[186:187], v29 offset:1920
    ds_read_b64_tr_b16 v[188:189], v29 offset:2304
    ds_read_b64_tr_b16 v[190:191], v29 offset:2688
    s_cmp_eq_u32 s93, 1
    s_cbranch_scc1 P2_b_max
    s_cmp_lg_u32 s86, 2
    s_cbranch_scc1 P2_cb2
    s_nop 7
    v_mov_b32 v80, v227
    v_mov_b32 v81, v227
    v_mov_b32 v82, v227
    v_mov_b32 v83, v227
    v_mov_b32 v84, v227
    v_mov_b32 v85, v227
    v_mov_b32 v86, v227
    v_mov_b32 v87, v227
    v_mov_b32 v88, v227
    v_mov_b32 v89, v227
    v_mov_b32 v90, v227
    v_mov_b32 v91, v227
    v_mov_b32 v92, v227
    v_mov_b32 v93, v227
    v_mov_b32 v94, v227
    v_mov_b32 v95, v227
    s_nop 1
P2_cb2:
    s_nop 7
    s_add_u32 s21, s28, 0
    s_mul_i32 s22, s21, 51200
    s_add_u32 s22, s22, s20
    s_lshr_b32 s23, s21, 2
    s_add_u32 s23, s23, s21
    s_mul_i32 s23, s23, 5120
    s_add_u32 m0, s23, 49152
    s_nop 0
    buffer_load_dwordx4 v36, s[16:19], s22 offen lds
    s_add_u32 m0, s23, 50176
    s_nop 0
    buffer_load_dwordx4 v37, s[16:19], s22 offen lds
    s_add_u32 m0, s23, 51200
    s_nop 0
    buffer_load_dwordx4 v38, s[16:19], s22 offen lds
    s_waitcnt lgkmcnt(4)
    v_mfma_f32_32x32x16_bf16 v[128:143], v[160:163], v[20:23], v[80:95]
    v_exp_f32 v112, v112
    v_exp_f32 v113, v113
    v_exp_f32 v114, v114
    v_exp_f32 v115, v115
    v_mfma_f32_32x32x16_bf16 v[128:143], v[164:167], v[24:27], v[128:143]
    ds_read_b128 v[168:171], v28 offset:4608
    ds_read_b128 v[172:175], v28 offset:5632
    v_exp_f32 v116, v116
    v_exp_f32 v117, v117
    v_exp_f32 v118, v118
    v_exp_f32 v119, v119
    v_exp_f32 v120, v120
    v_exp_f32 v121, v121
    v_exp_f32 v122, v122
    v_exp_f32 v123, v123
    ds_read_b64_tr_b16 v[176:177], v29 offset:3072
    ds_read_b64_tr_b16 v[178:179], v29 offset:3456
    ds_read_b64_tr_b16 v[180:181], v29 offset:3840
    ds_read_b64_tr_b16 v[182:183], v29 offset:4224
    v_exp_f32 v124, v124
    v_exp_f32 v125, v125
    v_exp_f32 v126, v126
    v_exp_f32 v127, v127
    v_cvt_pk_bf16_f32 v144, v112, v113
    v_cvt_pk_bf16_f32 v145, v114, v115
    v_cvt_pk_bf16_f32 v146, v116, v117
    v_cvt_pk_bf16_f32 v147, v118, v119
    v_cvt_pk_bf16_f32 v148, v120, v121
    v_cvt_pk_bf16_f32 v149, v122, v123
    v_cvt_pk_bf16_f32 v150, v124, v125
    v_cvt_pk_bf16_f32 v151, v126, v127
    s_cmp_lg_u32 s86, 3
    s_cbranch_scc1 P2_cb3
    s_nop 7
    v_mov_b32 v80, v227
    v_mov_b32 v81, v227
    v_mov_b32 v82, v227
    v_mov_b32 v83, v227
    v_mov_b32 v84, v227
    v_mov_b32 v85, v227
    v_mov_b32 v86, v227
    v_mov_b32 v87, v227
    v_mov_b32 v88, v227
    v_mov_b32 v89, v227
    v_mov_b32 v90, v227
    v_mov_b32 v91, v227
    v_mov_b32 v92, v227
    v_mov_b32 v93, v227
    v_mov_b32 v94, v227
    v_mov_b32 v95, v227
    s_nop 1
P2_cb3:
    s_add_u32 m0, s23, 52224
    s_nop 0
    buffer_load_dwordx4 v39, s[16:19], s22 offen lds
    s_add_u32 m0, s23, 53248
    s_nop 0
    buffer_load_dwordx4 v40, s[16:19], s22 offen lds
    s_waitcnt lgkmcnt(4)
    v_mfma_f32_32x32x16_bf16 v[112:127], v[168:171], v[20:23], v[80:95]
    v_exp_f32 v128, v128
    v_exp_f32 v129, v129
    v_exp_f32 v130, v130
    v_exp_f32 v131, v131
    v_mfma_f32_32x32x16_bf16 v[112:127], v[172:175], v[24:27], v[112:127]
    ds_read_b128 v[160:163], v28 offset:6144
    ds_read_b128 v[164:167], v28 offset:7168
    v_exp_f32 v132, v132
    v_exp_f32 v133, v133
    v_exp_f32 v134, v134
    v_exp_f32 v135, v135
    v_mfma_f32_32x32x16_bf16 v[192:207], v[184:187], v[144:147], 0
    v_exp_f32 v136, v136
    v_exp_f32 v137, v137
    v_exp_f32 v138, v138
    v_exp_f32 v139, v139
    v_mfma_f32_32x32x16_bf16 v[192:207], v[188:191], v[148:151], v[192:207]
    ds_read_b64_tr_b16 v[184:185], v29 offset:4608
    ds_read_b64_tr_b16 v[186:187], v29 offset:4992
    ds_read_b64_tr_b16 v[188:189], v29 offset:5376
    ds_read_b64_tr_b16 v[190:191], v29 offset:5760
    v_exp_f32 v140, v140
    v_exp_f32 v141, v141
    v_exp_f32 v142, v142
    v_exp_f32 v143, v143
    v_cvt_pk_bf16_f32 v152, v128, v129
    v_cvt_pk_bf16_f32 v153, v130, v131
    v_cvt_pk_bf16_f32 v154, v132, v133
    v_cvt_pk_bf16_f32 v155, v134, v135
    v_cvt_pk_bf16_f32 v156, v136, v137
    v_cvt_pk_bf16_f32 v157, v138, v139
    v_cvt_pk_bf16_f32 v158, v140, v141
    v_cvt_pk_bf16_f32 v159, v142, v143
    s_cmp_lg_u32 s86, 4
    s_cbranch_scc1 P2_cb4
    s_nop 7
    v_mov_b32 v80, v227
    v_mov_b32 v81, v227
    v_mov_b32 v82, v227
    v_mov_b32 v83, v227
    v_mov_b32 v84, v227
    v_mov_b32 v85, v227
    v_mov_b32 v86, v227
    v_mov_b32 v87, v227
    v_mov_b32 v88, v227
    v_mov_b32 v89, v227
    v_mov_b32 v90, v227
    v_mov_b32 v91, v227
    v_mov_b32 v92, v227
    v_mov_b32 v93, v227
    v_mov_b32 v94, v227
    v_mov_b32 v95, v227
    s_nop 1
P2_cb4:
    s_add_u32 s21, s28, 8
    s_mul_i32 s22, s21, 51200
    s_add_u32 s22, s22, s20
    s_lshr_b32 s23, s21, 2
    s_add_u32 s23, s23, s21
    s_mul_i32 s23, s23, 5120
    s_add_u32 m0, s23, 49152
    s_nop 0
    buffer_load_dwordx4 v36, s[16:19], s22 offen lds
    s_add_u32 m0, s23, 50176
    s_nop 0
    buffer_load_dwordx4 v37, s[16:19], s22 offen lds
    s_add_u32 m0, s23, 51200
    s_nop 0
    buffer_load_dwordx4 v38, s[16:19], s22 offen lds
    s_waitcnt lgkmcnt(4)
    v_mfma_f32_32x32x16_bf16 v[128:143], v[160:163], v[20:23], v[80:95]
    v_exp_f32 v112, v112
    v_exp_f32 v113, v113
    v_exp_f32 v114, v114
    v_exp_f32 v115, v115
    v_mfma_f32_32x32x16_bf16 v[128:143], v[164:167], v[24:27], v[128:143]
    ds_read_b128 v[168:171], v28 offset:7680
    ds_read_b128 v[172:175], v28 offset:8704
    v_exp_f32 v116, v116
    v_exp_f32 v117, v117
    v_exp_f32 v118, v118
    v_exp_f32 v119, v119
    v_mfma_f32_32x32x16_bf16 v[192:207], v[176:179], v[152:155], v[192:207]
    v_exp_f32 v120, v120
    v_exp_f32 v121, v121
    v_exp_f32 v122, v122
    v_exp_f32 v123, v123
    v_mfma_f32_32x32x16_bf16 v[192:207], v[180:183], v[156:159], v[192:207]
    ds_read_b64_tr_b16 v[176:177], v29 offset:6144
    ds_read_b64_tr_b16 v[178:179], v29 offset:6528
    ds_read_b64_tr_b16 v[180:181], v29 offset:6912
    ds_read_b64_tr_b16 v[182:183], v29 offset:7296
    v_exp_f32 v124, v124
    v_exp_f32 v125, v125
    v_exp_f32 v126, v126
    v_exp_f32 v127, v127
    v_cvt_pk_bf16_f32 v144, v112, v113
    v_cvt_pk_bf16_f32 v145, v114, v115
    v_cvt_pk_bf16_f32 v146, v116, v117
    v_cvt_pk_bf16_f32 v147, v118, v119
    v_cvt_pk_bf16_f32 v148, v120, v121
    v_cvt_pk_bf16_f32 v149, v122, v123
    v_cvt_pk_bf16_f32 v150, v124, v125
    v_cvt_pk_bf16_f32 v151, v126, v127
    s_cmp_lg_u32 s86, 5
    s_cbranch_scc1 P2_cb5
    s_nop 7
    v_mov_b32 v80, v227
    v_mov_b32 v81, v227
    v_mov_b32 v82, v227
    v_mov_b32 v83, v227
    v_mov_b32 v84, v227
    v_mov_b32 v85, v227
    v_mov_b32 v86, v227
    v_mov_b32 v87, v227
    v_mov_b32 v88, v227
    v_mov_b32 v89, v227
    v_mov_b32 v90, v227
    v_mov_b32 v91, v227
    v_mov_b32 v92, v227
    v_mov_b32 v93, v227
    v_mov_b32 v94, v227
    v_mov_b32 v95, v227
    s_nop 1
P2_cb5:
    s_add_u32 m0, s23, 52224
    s_nop 0
    buffer_load_dwordx4 v39, s[16:19], s22 offen lds
    s_add_u32 m0, s23, 53248
    s_nop 0
    buffer_load_dwordx4 v40, s[16:19], s22 offen lds
    s_waitcnt lgkmcnt(4)
    v_mfma_f32_32x32x16_bf16 v[112:127], v[168:171], v[20:23], v[80:95]
    v_exp_f32 v128, v128
    v_exp_f32 v129, v129
    v_exp_f32 v130, v130
    v_exp_f32 v131, v131
    v_mfma_f32_32x32x16_bf16 v[112:127], v[172:175], v[24:27], v[112:127]
    ds_read_b128 v[160:163], v28 offset:9216
    ds_read_b128 v[164:167], v28 offset:10240
    v_exp_f32 v132, v132
    v_exp_f32 v133, v133
    v_exp_f32 v134, v134
    v_exp_f32 v135, v135
    v_mfma_f32_32x32x16_bf16 v[192:207], v[184:187], v[144:147], v[192:207]
    v_exp_f32 v136, v136
    v_exp_f32 v137, v137
    v_exp_f32 v138, v138
    v_exp_f32 v139, v139
    v_mfma_f32_32x32x16_bf16 v[192:207], v[188:191], v[148:151], v[192:207]
    ds_read_b64_tr_b16 v[184:185], v29 offset:7680
    ds_read_b64_tr_b16 v[186:187], v29 offset:8064
    ds_read_b64_tr_b16 v[188:189], v29 offset:8448
    ds_read_b64_tr_b16 v[190:191], v29 offset:8832
    v_exp_f32 v140, v140
    v_exp_f32 v141, v141
    v_exp_f32 v142, v142
    v_exp_f32 v143, v143
    v_cvt_pk_bf16_f32 v152, v128, v129
    v_cvt_pk_bf16_f32 v153, v130, v131
    v_cvt_pk_bf16_f32 v154, v132, v133
    v_cvt_pk_bf16_f32 v155, v134, v135
    v_cvt_pk_bf16_f32 v156, v136, v137
    v_cvt_pk_bf16_f32 v157, v138, v139
    v_cvt_pk_bf16_f32 v158, v140, v141
    v_cvt_pk_bf16_f32 v159, v142, v143
    s_cmp_lg_u32 s86, 6
    s_cbranch_scc1 P2_cb6
    s_nop 7
    v_mov_b32 v80, v227
    v_mov_b32 v81, v227
    v_mov_b32 v82, v227
    v_mov_b32 v83, v227
    v_mov_b32 v84, v227
    v_mov_b32 v85, v227
    v_mov_b32 v86, v227
    v_mov_b32 v87, v227
    v_mov_b32 v88, v227
    v_mov_b32 v89, v227
    v_mov_b32 v90, v227
    v_mov_b32 v91, v227
    v_mov_b32 v92, v227
    v_mov_b32 v93, v227
    v_mov_b32 v94, v227
    v_mov_b32 v95, v227
    s_nop 1
P2_cb6:
    s_cmp_ge_u32 s28, 4
    s_cbranch_scc1 P2_nw5
    s_mul_i32 s22, s28, 204800
    s_add_u32 s22, s22, s20
    s_mul_i32 s23, s28, 25600
    s_add_u32 s23, s23, 20480
    s_add_u32 m0, s23, 49152
    s_nop 0
    buffer_load_dwordx4 v41, s[16:19], s22 offen lds
    s_add_u32 m0, s23, 50176
    s_nop 0
    buffer_load_dwordx4 v42, s[16:19], s22 offen lds
    s_add_u32 m0, s23, 51200
    s_nop 0
    buffer_load_dwordx4 v43, s[16:19], s22 offen lds
P2_nw5:
    s_waitcnt lgkmcnt(4)
    v_mfma_f32_32x32x16_bf16 v[128:143], v[160:163], v[20:23], v[80:95]
    v_exp_f32 v112, v112
    v_exp_f32 v113, v113
    v_exp_f32 v114, v114
    v_exp_f32 v115, v115
    v_mfma_f32_32x32x16_bf16 v[128:143], v[164:167], v[24:27], v[128:143]
    ds_read_b128 v[168:171], v28 offset:10752
    ds_read_b128 v[172:175], v28 offset:11776
    v_exp_f32 v116, v116
    v_exp_f32 v117, v117
    v_exp_f32 v118, v118
    v_exp_f32 v119, v119
    v_mfma_f32_32x32x16_bf16 v[192:207], v[176:179], v[152:155], v[192:207]
    v_exp_f32 v120, v120
    v_exp_f32 v121, v121
    v_exp_f32 v122, v122
    v_exp_f32 v123, v123
    v_mfma_f32_32x32x16_bf16 v[192:207], v[180:183], v[156:159], v[192:207]
    ds_read_b64_tr_b16 v[176:177], v29 offset:9216
    ds_read_b64_tr_b16 v[178:179], v29 offset:9600
    ds_read_b64_tr_b16 v[180:181], v29 offset:9984
    ds_read_b64_tr_b16 v[182:183], v29 offset:10368
    v_exp_f32 v124, v124
    v_exp_f32 v125, v125
    v_exp_f32 v126, v126
    v_exp_f32 v127, v127
    v_cvt_pk_bf16_f32 v144, v112, v113
    v_cvt_pk_bf16_f32 v145, v114, v115
    v_cvt_pk_bf16_f32 v146, v116, v117
    v_cvt_pk_bf16_f32 v147, v118, v119
    v_cvt_pk_bf16_f32 v148, v120, v121
    v_cvt_pk_bf16_f32 v149, v122, v123
    v_cvt_pk_bf16_f32 v150, v124, v125
    v_cvt_pk_bf16_f32 v151, v126, v127
    s_cmp_lg_u32 s86, 7
    s_cbranch_scc1 P2_cb7
    s_nop 7
    v_mov_b32 v80, v227
    v_mov_b32 v81, v227
    v_mov_b32 v82, v227
    v_mov_b32 v83, v227
    v_mov_b32 v84, v227
    v_mov_b32 v85, v227
    v_mov_b32 v86, v227
    v_mov_b32 v87, v227
    v_mov_b32 v88, v227
    v_mov_b32 v89, v227
    v_mov_b32 v90, v227
    v_mov_b32 v91, v227
    v_mov_b32 v92, v227
    v_mov_b32 v93, v227
    v_mov_b32 v94, v227
    v_mov_b32 v95, v227
    s_nop 1
P2_cb7:
    s_setprio 0
    s_cmp_ge_u32 s28, 4
    s_cbranch_scc1 P2_nw6
    s_add_u32 m0, s23, 52224
    s_nop 0
    buffer_load_dwordx4 v44, s[16:19], s22 offen lds
    s_add_u32 m0, s23, 53248
    s_nop 0
    buffer_load_dwordx4 v45, s[16:19], s22 offen lds
P2_nw6:
    s_waitcnt lgkmcnt(4)
    v_mfma_f32_32x32x16_bf16 v[112:127], v[168:171], v[20:23], v[80:95]
    v_exp_f32 v128, v128
    v_exp_f32 v129, v129
    v_exp_f32 v130, v130
    v_exp_f32 v131, v131
    v_mfma_f32_32x32x16_bf16 v[112:127], v[172:175], v[24:27], v[112:127]
    ds_read_b128 v[160:163], v28 offset:12288
    ds_read_b128 v[164:167], v28 offset:13312
    v_exp_f32 v132, v132
    v_exp_f32 v133, v133
    v_exp_f32 v134, v134
    v_exp_f32 v135, v135
    v_mfma_f32_32x32x16_bf16 v[192:207], v[184:187], v[144:147], v[192:207]
    v_exp_f32 v136, v136
    v_exp_f32 v137, v137
    v_exp_f32 v138, v138
    v_exp_f32 v139, v139
    v_mfma_f32_32x32x16_bf16 v[192:207], v[188:191], v[148:151], v[192:207]
    ds_read_b64_tr_b16 v[184:185], v29 offset:10752
    ds_read_b64_tr_b16 v[186:187], v29 offset:11136
    ds_read_b64_tr_b16 v[188:189], v29 offset:11520
    ds_read_b64_tr_b16 v[190:191], v29 offset:11904
    v_exp_f32 v140, v140
    v_exp_f32 v141, v141
    v_exp_f32 v142, v142
    v_exp_f32 v143, v143
    v_cvt_pk_bf16_f32 v152, v128, v129
    v_cvt_pk_bf16_f32 v153, v130, v131
    v_cvt_pk_bf16_f32 v154, v132, v133
    v_cvt_pk_bf16_f32 v155, v134, v135
    v_cvt_pk_bf16_f32 v156, v136, v137
    v_cvt_pk_bf16_f32 v157, v138, v139
    v_cvt_pk_bf16_f32 v158, v140, v141
    v_cvt_pk_bf16_f32 v159, v142, v143
    s_cmp_lg_u32 s86, 8
    s_cbranch_scc1 P2_cb8
    s_nop 7
    v_mov_b32 v80, v227
    v_mov_b32 v81, v227
    v_mov_b32 v82, v227
    v_mov_b32 v83, v227
    v_mov_b32 v84, v227
    v_mov_b32 v85, v227
    v_mov_b32 v86, v227
    v_mov_b32 v87, v227
    v_mov_b32 v88, v227
    v_mov_b32 v89, v227
    v_mov_b32 v90, v227
    v_mov_b32 v91, v227
    v_mov_b32 v92, v227
    v_mov_b32 v93, v227
    v_mov_b32 v94, v227
    v_mov_b32 v95, v227
    s_nop 1
P2_cb8:
    s_waitcnt lgkmcnt(4)
    v_mfma_f32_32x32x16_bf16 v[128:143], v[160:163], v[20:23], v[80:95]
    v_exp_f32 v112, v112
    v_exp_f32 v113, v113
    v_exp_f32 v114, v114
    v_exp_f32 v115, v115
    v_mfma_f32_32x32x16_bf16 v[128:143], v[164:167], v[24:27], v[128:143]
    v_exp_f32 v116, v116
    v_exp_f32 v117, v117
    v_exp_f32 v118, v118
    v_exp_f32 v119, v119
    v_mfma_f32_32x32x16_bf16 v[192:207], v[176:179], v[152:155], v[192:207]
    v_exp_f32 v120, v120
    v_exp_f32 v121, v121
    v_exp_f32 v122, v122
    v_exp_f32 v123, v123
    v_mfma_f32_32x32x16_bf16 v[192:207], v[180:183], v[156:159], v[192:207]
    ds_read_b64_tr_b16 v[176:177], v29 offset:0
    ds_read_b64_tr_b16 v[178:179], v29 offset:384
    ds_read_b64_tr_b16 v[180:181], v29 offset:768
    ds_read_b64_tr_b16 v[182:183], v29 offset:1152
    v_exp_f32 v124, v124
    v_exp_f32 v125, v125
    v_exp_f32 v126, v126
    v_exp_f32 v127, v127
    v_cvt_pk_bf16_f32 v144, v112, v113
    v_cvt_pk_bf16_f32 v145, v114, v115
    v_cvt_pk_bf16_f32 v146, v116, v117
    v_cvt_pk_bf16_f32 v147, v118, v119
    v_cvt_pk_bf16_f32 v148, v120, v121
    v_cvt_pk_bf16_f32 v149, v122, v123
    v_cvt_pk_bf16_f32 v150, v124, v125
    v_cvt_pk_bf16_f32 v151, v126, v127
    v_cndmask_b32 v96, v96, v128, s[52:53]
    v_cndmask_b32 v97, v97, v129, s[54:55]
    v_cndmask_b32 v98, v98, v130, s[56:57]
    v_cndmask_b32 v99, v99, v131, s[58:59]
    s_waitcnt lgkmcnt(4)
    v_mfma_f32_32x32x16_bf16 v[192:207], v[184:187], v[144:147], v[192:207]
    v_cndmask_b32 v100, v100, v132, s[60:61]
    v_cndmask_b32 v101, v101, v133, s[62:63]
    v_cndmask_b32 v102, v102, v134, s[64:65]
    v_cndmask_b32 v103, v103, v135, s[66:67]
    v_cndmask_b32 v104, v104, v136, s[68:69]
    v_cndmask_b32 v105, v105, v137, s[70:71]
    v_cndmask_b32 v106, v106, v138, s[72:73]
    v_cndmask_b32 v107, v107, v139, s[74:75]
    v_mfma_f32_32x32x16_bf16 v[192:207], v[188:191], v[148:151], v[192:207]
    ds_read_b64_tr_b16 v[184:185], v29 offset:12288
    ds_read_b64_tr_b16 v[186:187], v29 offset:12672
    ds_read_b64_tr_b16 v[188:189], v29 offset:13056
    ds_read_b64_tr_b16 v[190:191], v29 offset:13440
    v_cndmask_b32 v108, v108, v140, s[76:77]
    v_cndmask_b32 v109, v109, v141, s[78:79]
    v_cndmask_b32 v110, v110, v142, s[80:81]
    v_cndmask_b32 v111, v111, v143, s[82:83]
    v_exp_f32 v96, v96
    v_exp_f32 v97, v97
    v_exp_f32 v98, v98
    v_exp_f32 v99, v99
    v_exp_f32 v100, v100
    v_exp_f32 v101, v101
    v_exp_f32 v102, v102
    v_exp_f32 v103, v103
    v_exp_f32 v104, v104
    v_exp_f32 v105, v105
    v_exp_f32 v106, v106
    v_exp_f32 v107, v107
    v_exp_f32 v108, v108
    v_exp_f32 v109, v109
    v_exp_f32 v110, v110
    v_exp_f32 v111, v111
    s_nop 0
    v_cvt_pk_bf16_f32 v152, v96, v97
    v_cvt_pk_bf16_f32 v153, v98, v99
    v_cvt_pk_bf16_f32 v154, v100, v101
    v_cvt_pk_bf16_f32 v155, v102, v103
    v_cvt_pk_bf16_f32 v156, v104, v105
    v_cvt_pk_bf16_f32 v157, v106, v107
    v_cvt_pk_bf16_f32 v158, v108, v109
    v_cvt_pk_bf16_f32 v159, v110, v111
    v_and_b32 v64, v152, v214
    v_bfi_b32 v152, v214, 0, v152
    v_and_b32 v65, v153, v215
    v_bfi_b32 v153, v215, 0, v153
    v_and_b32 v66, v154, v216
    v_bfi_b32 v154, v216, 0, v154
    v_and_b32 v67, v155, v217
    v_bfi_b32 v155, v217, 0, v155
    v_and_b32 v68, v156, v218
    v_bfi_b32 v156, v218, 0, v156
    v_and_b32 v69, v157, v219
    v_bfi_b32 v157, v219, 0, v157
    v_and_b32 v70, v158, v220
    v_bfi_b32 v158, v220, 0, v158
    v_and_b32 v71, v159, v221
    v_bfi_b32 v159, v221, 0, v159
    s_waitcnt lgkmcnt(0)
    s_nop 0
    v_mfma_f32_32x32x16_bf16 v[192:207], v[176:179], v[152:155], v[192:207]
    v_mfma_f32_32x32x16_bf16 v[192:207], v[180:183], v[156:159], v[192:207]
    v_mfma_f32_32x32x16_bf16 v[192:207], v[184:187], v[64:67], v[192:207]
    v_mfma_f32_32x32x16_bf16 v[192:207], v[188:191], v[68:71], v[192:207]
    s_nop 7
    s_nop 3
    v_rcp_f32 v228, v204
    v_add_f32 v229, |v192|, |v193|
    v_add_f32 v229, v229, |v194|
    v_add_f32 v229, v229, |v195|
    v_add_f32 v229, v229, |v196|
    v_add_f32 v229, v229, |v197|
    v_add_f32 v229, v229, |v198|
    v_add_f32 v229, v229, |v199|
    v_add_f32 v229, v229, |v200|
    v_add_f32 v229, v229, |v201|
    v_add_f32 v229, v229, |v202|
    v_add_f32 v229, v229, |v203|
    v_cmp_le_f32 s[88:89], s84, v204
    v_cmp_ge_f32 s[90:91], s85, v204
    v_cmp_gt_f32 vcc, -v223, v229
    v_mul_f32 v192, v192, v228
    v_mul_f32 v193, v193, v228
    v_mul_f32 v194, v194, v228
    v_mul_f32 v195, v195, v228
    v_mul_f32 v196, v196, v228
    v_mul_f32 v197, v197, v228
    v_mul_f32 v198, v198, v228
    v_mul_f32 v199, v199, v228
    v_mul_f32 v200, v200, v228
    v_mul_f32 v201, v201, v228
    v_mul_f32 v202, v202, v228
    v_mul_f32 v203, v203, v228
    s_and_b64 s[88:89], s[88:89], s[90:91]
    s_and_b64 s[88:89], s[88:89], vcc
    s_or_b32 s90, s93, 0
    s_cbranch_scc1 P2_b_ok
    s_cmp_eq_u64 s[88:89], exec
    s_cbranch_scc0 P2_b_fb
P2_b_ok:
    v_cvt_pk_bf16_f32 v192, v192, v193
    v_cvt_pk_bf16_f32 v193, v194, v195
    v_cvt_pk_bf16_f32 v194, v196, v197
    v_cvt_pk_bf16_f32 v195, v198, v199
    v_cvt_pk_bf16_f32 v196, v200, v201
    v_cvt_pk_bf16_f32 v197, v202, v203
    s_mov_b32 s88, 2621440
    v_permlane32_swap_b32 v192, v194
    v_permlane32_swap_b32 v193, v195
    buffer_store_dwordx2 v[196:197], v33, s[24:27], s88 offen sc1
    buffer_store_dwordx4 v[192:195], v32, s[24:27], s88 offen sc1
    s_cmp_lt_u32 s28, 4
    s_cbranch_scc1 P3
    s_waitcnt vmcnt(0)
    s_barrier
    s_cmp_lg_u32 s28, 4
    s_cbranch_scc1 H_poll
    buffer_store_dwordx2 v[250:251], v19, s[96:99], 0 offen sc1
H_poll:
    s_lshl_b32 s12, s5, 7
    s_lshl_b32 s13, s9, 3
    s_add_u32 s12, s12, s13
    s_add_u32 s12, s12, s10
    s_lshl_b32 s12, s12, 9
    s_add_u32 s12, s12, 25296896
    s_and_b32 s13, s28, 3
    s_lshl_b32 s13, s13, 7
    s_mul_i32 s13, s13, s5
    s_add_u32 s40, s12, s13
    s_mov_b32 s94, 0
    s_and_b32 s12, s28, 3
    s_lshl_b32 s12, s12, 3
    v_mov_b32 v2, s12
H_loop:
    s_load_dwordx16 s[52:67], s[48:49], s40 glc
    s_add_u32 s94, s94, 1
    s_cmp_ge_u32 s94, 131072
    s_waitcnt lgkmcnt(0)
    s_cbranch_scc1 H_done
    s_xor_b64 s[88:89], s[52:53], s[0:1]
    s_xor_b64 s[90:91], s[54:55], s[0:1]
    s_or_b64 s[88:89], s[88:89], s[90:91]
    s_xor_b64 s[90:91], s[56:57], s[0:1]
    s_or_b64 s[88:89], s[88:89], s[90:91]
    s_xor_b64 s[90:91], s[58:59], s[0:1]
    s_or_b64 s[88:89], s[88:89], s[90:91]
    s_xor_b64 s[90:91], s[60:61], s[0:1]
    s_or_b64 s[88:89], s[88:89], s[90:91]
    s_xor_b64 s[90:91], s[62:63], s[0:1]
    s_or_b64 s[88:89], s[88:89], s[90:91]
    s_xor_b64 s[90:91], s[64:65], s[0:1]
    s_or_b64 s[88:89], s[88:89], s[90:91]
    s_xor_b64 s[90:91], s[66:67], s[0:1]
    s_or_b64 s[88:89], s[88:89], s[90:91]
    s_cbranch_scc1 H_loop
H_done:
    ds_write_b64 v2, v[250:251]
    s_waitcnt lgkmcnt(0)
    s_branch K_end2
P2_a_inv:
    s_nop 3
    v_mov_b32 v112, v223
    v_mov_b32 v113, v223
    v_mov_b32 v114, v223
    v_mov_b32 v115, v223
    v_mov_b32 v116, v223
    v_mov_b32 v117, v223
    v_mov_b32 v118, v223
    v_mov_b32 v119, v223
    v_mov_b32 v120, v223
    v_mov_b32 v121, v223
    v_mov_b32 v122, v223
    v_mov_b32 v123, v223
    v_mov_b32 v124, v223
    v_mov_b32 v125, v223
    v_mov_b32 v126, v223
    v_mov_b32 v127, v223
    s_branch P2_a_val
P2_a_rst:
    s_mov_b32 s92, 0
    v_mov_b32 v227, 0
    v_subrev_u32 v228, 0, v222
    v_and_b32 v228, 17, v228
    v_cmp_eq_u32 s[88:89], 0, v228
    s_nop 1
    v_cndmask_b32 v230, v223, v227, s[88:89]
    v_subrev_u32 v228, 1, v222
    v_and_b32 v228, 17, v228
    v_cmp_eq_u32 s[88:89], 0, v228
    s_nop 1
    v_cndmask_b32 v231, v223, v227, s[88:89]
    v_subrev_u32 v228, 2, v222
    v_and_b32 v228, 17, v228
    v_cmp_eq_u32 s[88:89], 0, v228
    s_nop 1
    v_cndmask_b32 v232, v223, v227, s[88:89]
    v_subrev_u32 v228, 3, v222
    v_and_b32 v228, 17, v228
    v_cmp_eq_u32 s[88:89], 0, v228
    s_nop 1
    v_cndmask_b32 v233, v223, v227, s[88:89]
    v_subrev_u32 v228, 8, v222
    v_and_b32 v228, 17, v228
    v_cmp_eq_u32 s[88:89], 0, v228
    s_nop 1
    v_cndmask_b32 v234, v223, v227, s[88:89]
    v_subrev_u32 v228, 9, v222
    v_and_b32 v228, 17, v228
    v_cmp_eq_u32 s[88:89], 0, v228
    s_nop 1
    v_cndmask_b32 v235, v223, v227, s[88:89]
    v_subrev_u32 v228, 10, v222
    v_and_b32 v228, 17, v228
    v_cmp_eq_u32 s[88:89], 0, v228
    s_nop 1
    v_cndmask_b32 v236, v223, v227, s[88:89]
    v_subrev_u32 v228, 11, v222
    v_and_b32 v228, 17, v228
    v_cmp_eq_u32 s[88:89], 0, v228
    s_nop 1
    v_cndmask_b32 v237, v223, v227, s[88:89]
    v_subrev_u32 v228, 16, v222
    v_and_b32 v228, 17, v228
    v_cmp_eq_u32 s[88:89], 0, v228
    s_nop 1
    v_cndmask_b32 v238, v223, v227, s[88:89]
    v_subrev_u32 v228, 17, v222
    v_and_b32 v228, 17, v228
    v_cmp_eq_u32 s[88:89], 0, v228
    s_nop 1
    v_cndmask_b32 v239, v223, v227, s[88:89]
    v_subrev_u32 v228, 18, v222
    v_and_b32 v228, 17, v228
    v_cmp_eq_u32 s[88:89], 0, v228
    s_nop 1
    v_cndmask_b32 v240, v223, v227, s[88:89]
    v_subrev_u32 v228, 19, v222
    v_and_b32 v228, 17, v228
    v_cmp_eq_u32 s[88:89], 0, v228
    s_nop 1
    v_cndmask_b32 v241, v223, v227, s[88:89]
    v_subrev_u32 v228, 24, v222
    v_and_b32 v228, 17, v228
    v_cmp_eq_u32 s[88:89], 0, v228
    s_nop 1
    v_cndmask_b32 v242, v223, v227, s[88:89]
    v_subrev_u32 v228, 25, v222
    v_and_b32 v228, 17, v228
    v_cmp_eq_u32 s[88:89], 0, v228
    s_nop 1
    v_cndmask_b32 v243, v223, v227, s[88:89]
    v_subrev_u32 v228, 26, v222
    v_and_b32 v228, 17, v228
    v_cmp_eq_u32 s[88:89], 0, v228
    s_nop 1
    v_cndmask_b32 v244, v223, v227, s[88:89]
    v_subrev_u32 v228, 27, v222
    v_and_b32 v228, 17, v228
    v_cmp_eq_u32 s[88:89], 0, v228
    s_nop 1
    v_cndmask_b32 v245, v223, v227, s[88:89]
    s_branch P2_a_next
P2_a_fb:
    s_mov_b32 s92, 1
    s_waitcnt lgkmcnt(0)
    s_branch P2_a_start
P2_a_max:
    v_max_f32 v229, v112, v113
    v_max3_f32 v229, v229, v114, v115
    v_max3_f32 v229, v229, v116, v117
    v_max3_f32 v229, v229, v118, v119
    v_max3_f32 v229, v229, v120, v121
    v_max3_f32 v229, v229, v122, v123
    v_max3_f32 v229, v229, v124, v125
    v_max3_f32 v229, v229, v126, v127
    v_mov_b32 v228, v229
    s_nop 1
    v_permlane32_swap_b32 v229, v228
    s_nop 1
    v_max_f32 v229, v229, v228
    v_sub_f32 v227, 0, v229
    s_mov_b32 s92, 2
    v_subrev_u32 v228, 0, v222
    v_and_b32 v228, 17, v228
    v_cmp_eq_u32 s[88:89], 0, v228
    s_nop 1
    v_cndmask_b32 v230, v223, v227, s[88:89]
    v_subrev_u32 v228, 1, v222
    v_and_b32 v228, 17, v228
    v_cmp_eq_u32 s[88:89], 0, v228
    s_nop 1
    v_cndmask_b32 v231, v223, v227, s[88:89]
    v_subrev_u32 v228, 2, v222
    v_and_b32 v228, 17, v228
    v_cmp_eq_u32 s[88:89], 0, v228
    s_nop 1
    v_cndmask_b32 v232, v223, v227, s[88:89]
    v_subrev_u32 v228, 3, v222
    v_and_b32 v228, 17, v228
    v_cmp_eq_u32 s[88:89], 0, v228
    s_nop 1
    v_cndmask_b32 v233, v223, v227, s[88:89]
    v_subrev_u32 v228, 8, v222
    v_and_b32 v228, 17, v228
    v_cmp_eq_u32 s[88:89], 0, v228
    s_nop 1
    v_cndmask_b32 v234, v223, v227, s[88:89]
    v_subrev_u32 v228, 9, v222
    v_and_b32 v228, 17, v228
    v_cmp_eq_u32 s[88:89], 0, v228
    s_nop 1
    v_cndmask_b32 v235, v223, v227, s[88:89]
    v_subrev_u32 v228, 10, v222
    v_and_b32 v228, 17, v228
    v_cmp_eq_u32 s[88:89], 0, v228
    s_nop 1
    v_cndmask_b32 v236, v223, v227, s[88:89]
    v_subrev_u32 v228, 11, v222
    v_and_b32 v228, 17, v228
    v_cmp_eq_u32 s[88:89], 0, v228
    s_nop 1
    v_cndmask_b32 v237, v223, v227, s[88:89]
    v_subrev_u32 v228, 16, v222
    v_and_b32 v228, 17, v228
    v_cmp_eq_u32 s[88:89], 0, v228
    s_nop 1
    v_cndmask_b32 v238, v223, v227, s[88:89]
    v_subrev_u32 v228, 17, v222
    v_and_b32 v228, 17, v228
    v_cmp_eq_u32 s[88:89], 0, v228
    s_nop 1
    v_cndmask_b32 v239, v223, v227, s[88:89]
    v_subrev_u32 v228, 18, v222
    v_and_b32 v228, 17, v228
    v_cmp_eq_u32 s[88:89], 0, v228
    s_nop 1
    v_cndmask_b32 v240, v223, v227, s[88:89]
    v_subrev_u32 v228, 19, v222
    v_and_b32 v228, 17, v228
    v_cmp_eq_u32 s[88:89], 0, v228
    s_nop 1
    v_cndmask_b32 v241, v223, v227, s[88:89]
    v_subrev_u32 v228, 24, v222
    v_and_b32 v228, 17, v228
    v_cmp_eq_u32 s[88:89], 0, v228
    s_nop 1
    v_cndmask_b32 v242, v223, v227, s[88:89]
    v_subrev_u32 v228, 25, v222
    v_and_b32 v228, 17, v228
    v_cmp_eq_u32 s[88:89], 0, v228
    s_nop 1
    v_cndmask_b32 v243, v223, v227, s[88:89]
    v_subrev_u32 v228, 26, v222
    v_and_b32 v228, 17, v228
    v_cmp_eq_u32 s[88:89], 0, v228
    s_nop 1
    v_cndmask_b32 v244, v223, v227, s[88:89]
    v_subrev_u32 v228, 27, v222
    v_and_b32 v228, 17, v228
    v_cmp_eq_u32 s[88:89], 0, v228
    s_nop 1
    v_cndmask_b32 v245, v223, v227, s[88:89]
    s_waitcnt lgkmcnt(0)
    s_branch P2_a_start
P2_b_fb:
    s_mov_b32 s93, 1
    s_cmp_eq_u32 s4, 0
    s_cselect_b64 s[88:89], exec, 0
    s_nop 1
    v_cndmask_b32 v80, v227, v223, s[88:89]
    v_cndmask_b32 v81, v227, v223, s[88:89]
    v_cndmask_b32 v82, v227, v223, s[88:89]
    v_cndmask_b32 v83, v227, v223, s[88:89]
    v_cndmask_b32 v84, v227, v223, s[88:89]
    v_cndmask_b32 v85, v227, v223, s[88:89]
    v_cndmask_b32 v86, v227, v223, s[88:89]
    v_cndmask_b32 v87, v227, v223, s[88:89]
    v_cndmask_b32 v88, v227, v223, s[88:89]
    v_cndmask_b32 v89, v227, v223, s[88:89]
    v_cndmask_b32 v90, v227, v223, s[88:89]
    v_cndmask_b32 v91, v227, v223, s[88:89]
    v_cndmask_b32 v92, v227, v223, s[88:89]
    v_cndmask_b32 v93, v227, v223, s[88:89]
    v_cndmask_b32 v94, v227, v223, s[88:89]
    v_cndmask_b32 v95, v227, v223, s[88:89]
    s_branch P2_b_start
P2_b_max:
    s_waitcnt lgkmcnt(0)
    s_nop 7
    s_nop 3
    v_max_f32 v229, v112, v113
    v_max3_f32 v229, v229, v114, v115
    v_max3_f32 v229, v229, v116, v117
    v_max3_f32 v229, v229, v118, v119
    v_max3_f32 v229, v229, v120, v121
    v_max3_f32 v229, v229, v122, v123
    v_max3_f32 v229, v229, v124, v125
    v_max3_f32 v229, v229, v126, v127
    s_cmp_lg_u32 s86, 2
    s_cbranch_scc1 P2_mcb2
    v_mov_b32 v80, v227
    v_mov_b32 v81, v227
    v_mov_b32 v82, v227
    v_mov_b32 v83, v227
    v_mov_b32 v84, v227
    v_mov_b32 v85, v227
    v_mov_b32 v86, v227
    v_mov_b32 v87, v227
    v_mov_b32 v88, v227
    v_mov_b32 v89, v227
    v_mov_b32 v90, v227
    v_mov_b32 v91, v227
    v_mov_b32 v92, v227
    v_mov_b32 v93, v227
    v_mov_b32 v94, v227
    v_mov_b32 v95, v227
P2_mcb2:
    ds_read_b128 v[160:163], v28 offset:3072
    ds_read_b128 v[164:167], v28 offset:4096
    s_waitcnt lgkmcnt(0)
    v_mfma_f32_32x32x16_bf16 v[112:127], v[160:163], v[20:23], v[80:95]
    v_mfma_f32_32x32x16_bf16 v[112:127], v[164:167], v[24:27], v[112:127]
    s_nop 7
    s_nop 7
    v_max3_f32 v229, v229, v112, v113
    v_max3_f32 v229, v229, v114, v115
    v_max3_f32 v229, v229, v116, v117
    v_max3_f32 v229, v229, v118, v119
    v_max3_f32 v229, v229, v120, v121
    v_max3_f32 v229, v229, v122, v123
    v_max3_f32 v229, v229, v124, v125
    v_max3_f32 v229, v229, v126, v127
    s_cmp_lg_u32 s86, 3
    s_cbranch_scc1 P2_mcb3
    v_mov_b32 v80, v227
    v_mov_b32 v81, v227
    v_mov_b32 v82, v227
    v_mov_b32 v83, v227
    v_mov_b32 v84, v227
    v_mov_b32 v85, v227
    v_mov_b32 v86, v227
    v_mov_b32 v87, v227
    v_mov_b32 v88, v227
    v_mov_b32 v89, v227
    v_mov_b32 v90, v227
    v_mov_b32 v91, v227
    v_mov_b32 v92, v227
    v_mov_b32 v93, v227
    v_mov_b32 v94, v227
    v_mov_b32 v95, v227
P2_mcb3:
    ds_read_b128 v[160:163], v28 offset:4608
    ds_read_b128 v[164:167], v28 offset:5632
    s_waitcnt lgkmcnt(0)
    v_mfma_f32_32x32x16_bf16 v[112:127], v[160:163], v[20:23], v[80:95]
    v_mfma_f32_32x32x16_bf16 v[112:127], v[164:167], v[24:27], v[112:127]
    s_nop 7
    s_nop 7
    v_max3_f32 v229, v229, v112, v113
    v_max3_f32 v229, v229, v114, v115
    v_max3_f32 v229, v229, v116, v117
    v_max3_f32 v229, v229, v118, v119
    v_max3_f32 v229, v229, v120, v121
    v_max3_f32 v229, v229, v122, v123
    v_max3_f32 v229, v229, v124, v125
    v_max3_f32 v229, v229, v126, v127
    s_cmp_lg_u32 s86, 4
    s_cbranch_scc1 P2_mcb4
    v_mov_b32 v80, v227
    v_mov_b32 v81, v227
    v_mov_b32 v82, v227
    v_mov_b32 v83, v227
    v_mov_b32 v84, v227
    v_mov_b32 v85, v227
    v_mov_b32 v86, v227
    v_mov_b32 v87, v227
    v_mov_b32 v88, v227
    v_mov_b32 v89, v227
    v_mov_b32 v90, v227
    v_mov_b32 v91, v227
    v_mov_b32 v92, v227
    v_mov_b32 v93, v227
    v_mov_b32 v94, v227
    v_mov_b32 v95, v227
P2_mcb4:
    ds_read_b128 v[160:163], v28 offset:6144
    ds_read_b128 v[164:167], v28 offset:7168
    s_waitcnt lgkmcnt(0)
    v_mfma_f32_32x32x16_bf16 v[112:127], v[160:163], v[20:23], v[80:95]
    v_mfma_f32_32x32x16_bf16 v[112:127], v[164:167], v[24:27], v[112:127]
    s_nop 7
    s_nop 7
    v_max3_f32 v229, v229, v112, v113
    v_max3_f32 v229, v229, v114, v115
    v_max3_f32 v229, v229, v116, v117
    v_max3_f32 v229, v229, v118, v119
    v_max3_f32 v229, v229, v120, v121
    v_max3_f32 v229, v229, v122, v123
    v_max3_f32 v229, v229, v124, v125
    v_max3_f32 v229, v229, v126, v127
    s_cmp_lg_u32 s86, 5
    s_cbranch_scc1 P2_mcb5
    v_mov_b32 v80, v227
    v_mov_b32 v81, v227
    v_mov_b32 v82, v227
    v_mov_b32 v83, v227
    v_mov_b32 v84, v227
    v_mov_b32 v85, v227
    v_mov_b32 v86, v227
    v_mov_b32 v87, v227
    v_mov_b32 v88, v227
    v_mov_b32 v89, v227
    v_mov_b32 v90, v227
    v_mov_b32 v91, v227
    v_mov_b32 v92, v227
    v_mov_b32 v93, v227
    v_mov_b32 v94, v227
    v_mov_b32 v95, v227
P2_mcb5:
    ds_read_b128 v[160:163], v28 offset:7680
    ds_read_b128 v[164:167], v28 offset:8704
    s_waitcnt lgkmcnt(0)
    v_mfma_f32_32x32x16_bf16 v[112:127], v[160:163], v[20:23], v[80:95]
    v_mfma_f32_32x32x16_bf16 v[112:127], v[164:167], v[24:27], v[112:127]
    s_nop 7
    s_nop 7
    v_max3_f32 v229, v229, v112, v113
    v_max3_f32 v229, v229, v114, v115
    v_max3_f32 v229, v229, v116, v117
    v_max3_f32 v229, v229, v118, v119
    v_max3_f32 v229, v229, v120, v121
    v_max3_f32 v229, v229, v122, v123
    v_max3_f32 v229, v229, v124, v125
    v_max3_f32 v229, v229, v126, v127
    s_cmp_lg_u32 s86, 6
    s_cbranch_scc1 P2_mcb6
    v_mov_b32 v80, v227
    v_mov_b32 v81, v227
    v_mov_b32 v82, v227
    v_mov_b32 v83, v227
    v_mov_b32 v84, v227
    v_mov_b32 v85, v227
    v_mov_b32 v86, v227
    v_mov_b32 v87, v227
    v_mov_b32 v88, v227
    v_mov_b32 v89, v227
    v_mov_b32 v90, v227
    v_mov_b32 v91, v227
    v_mov_b32 v92, v227
    v_mov_b32 v93, v227
    v_mov_b32 v94, v227
    v_mov_b32 v95, v227
P2_mcb6:
    ds_read_b128 v[160:163], v28 offset:9216
    ds_read_b128 v[164:167], v28 offset:10240
    s_waitcnt lgkmcnt(0)
    v_mfma_f32_32x32x16_bf16 v[112:127], v[160:163], v[20:23], v[80:95]
    v_mfma_f32_32x32x16_bf16 v[112:127], v[164:167], v[24:27], v[112:127]
    s_nop 7
    s_nop 7
    v_max3_f32 v229, v229, v112, v113
    v_max3_f32 v229, v229, v114, v115
    v_max3_f32 v229, v229, v116, v117
    v_max3_f32 v229, v229, v118, v119
    v_max3_f32 v229, v229, v120, v121
    v_max3_f32 v229, v229, v122, v123
    v_max3_f32 v229, v229, v124, v125
    v_max3_f32 v229, v229, v126, v127
    s_cmp_lg_u32 s86, 7
    s_cbranch_scc1 P2_mcb7
    v_mov_b32 v80, v227
    v_mov_b32 v81, v227
    v_mov_b32 v82, v227
    v_mov_b32 v83, v227
    v_mov_b32 v84, v227
    v_mov_b32 v85, v227
    v_mov_b32 v86, v227
    v_mov_b32 v87, v227
    v_mov_b32 v88, v227
    v_mov_b32 v89, v227
    v_mov_b32 v90, v227
    v_mov_b32 v91, v227
    v_mov_b32 v92, v227
    v_mov_b32 v93, v227
    v_mov_b32 v94, v227
    v_mov_b32 v95, v227
P2_mcb7:
    ds_read_b128 v[160:163], v28 offset:10752
    ds_read_b128 v[164:167], v28 offset:11776
    s_waitcnt lgkmcnt(0)
    v_mfma_f32_32x32x16_bf16 v[112:127], v[160:163], v[20:23], v[80:95]
    v_mfma_f32_32x32x16_bf16 v[112:127], v[164:167], v[24:27], v[112:127]
    s_nop 7
    s_nop 7
    v_max3_f32 v229, v229, v112, v113
    v_max3_f32 v229, v229, v114, v115
    v_max3_f32 v229, v229, v116, v117
    v_max3_f32 v229, v229, v118, v119
    v_max3_f32 v229, v229, v120, v121
    v_max3_f32 v229, v229, v122, v123
    v_max3_f32 v229, v229, v124, v125
    v_max3_f32 v229, v229, v126, v127
    s_cmp_lg_u32 s86, 8
    s_cbranch_scc1 P2_mcb8
    v_mov_b32 v80, v227
    v_mov_b32 v81, v227
    v_mov_b32 v82, v227
    v_mov_b32 v83, v227
    v_mov_b32 v84, v227
    v_mov_b32 v85, v227
    v_mov_b32 v86, v227
    v_mov_b32 v87, v227
    v_mov_b32 v88, v227
    v_mov_b32 v89, v227
    v_mov_b32 v90, v227
    v_mov_b32 v91, v227
    v_mov_b32 v92, v227
    v_mov_b32 v93, v227
    v_mov_b32 v94, v227
    v_mov_b32 v95, v227
P2_mcb8:
    ds_read_b128 v[160:163], v28 offset:12288
    ds_read_b128 v[164:167], v28 offset:13312
    s_waitcnt lgkmcnt(0)
    v_mfma_f32_32x32x16_bf16 v[112:127], v[160:163], v[20:23], v[80:95]
    v_mfma_f32_32x32x16_bf16 v[112:127], v[164:167], v[24:27], v[112:127]
    s_nop 7
    s_nop 7
    v_cndmask_b32 v112, v96, v112, s[52:53]
    v_cndmask_b32 v113, v97, v113, s[54:55]
    v_cndmask_b32 v114, v98, v114, s[56:57]
    v_cndmask_b32 v115, v99, v115, s[58:59]
    v_cndmask_b32 v116, v100, v116, s[60:61]
    v_cndmask_b32 v117, v101, v117, s[62:63]
    v_cndmask_b32 v118, v102, v118, s[64:65]
    v_cndmask_b32 v119, v103, v119, s[66:67]
    v_cndmask_b32 v120, v104, v120, s[68:69]
    v_cndmask_b32 v121, v105, v121, s[70:71]
    v_cndmask_b32 v122, v106, v122, s[72:73]
    v_cndmask_b32 v123, v107, v123, s[74:75]
    v_cndmask_b32 v124, v108, v124, s[76:77]
    v_cndmask_b32 v125, v109, v125, s[78:79]
    v_cndmask_b32 v126, v110, v126, s[80:81]
    v_cndmask_b32 v127, v111, v127, s[82:83]
    v_max3_f32 v229, v229, v112, v113
    v_max3_f32 v229, v229, v114, v115
    v_max3_f32 v229, v229, v116, v117
    v_max3_f32 v229, v229, v118, v119
    v_max3_f32 v229, v229, v120, v121
    v_max3_f32 v229, v229, v122, v123
    v_max3_f32 v229, v229, v124, v125
    v_max3_f32 v229, v229, v126, v127
    v_mov_b32 v228, v229
    s_nop 1
    v_permlane32_swap_b32 v229, v228
    s_nop 1
    v_max_f32 v229, v229, v228
    v_sub_f32 v227, 0, v229
    s_mov_b32 s93, 2
    s_cmp_eq_u32 s4, 0
    s_cselect_b64 s[88:89], exec, 0
    s_nop 1
    v_cndmask_b32 v80, v227, v223, s[88:89]
    v_cndmask_b32 v81, v227, v223, s[88:89]
    v_cndmask_b32 v82, v227, v223, s[88:89]
    v_cndmask_b32 v83, v227, v223, s[88:89]
    v_cndmask_b32 v84, v227, v223, s[88:89]
    v_cndmask_b32 v85, v227, v223, s[88:89]
    v_cndmask_b32 v86, v227, v223, s[88:89]
    v_cndmask_b32 v87, v227, v223, s[88:89]
    v_cndmask_b32 v88, v227, v223, s[88:89]
    v_cndmask_b32 v89, v227, v223, s[88:89]
    v_cndmask_b32 v90, v227, v223, s[88:89]
    v_cndmask_b32 v91, v227, v223, s[88:89]
    v_cndmask_b32 v92, v227, v223, s[88:89]
    v_cndmask_b32 v93, v227, v223, s[88:89]
    v_cndmask_b32 v94, v227, v223, s[88:89]
    v_cndmask_b32 v95, v227, v223, s[88:89]
    s_waitcnt lgkmcnt(0)
    s_branch P2_b_start
P3_acq1:
    ds_read_b64 v[4:5], v12
    s_waitcnt lgkmcnt(0)
    v_cmp_eq_u64 vcc, s[0:1], v[4:5]
    s_nop 1
    s_or_b32 s22, s22, vcc_lo
    s_bitcmp1_b32 s22, 3
    s_cselect_b32 s23, 1, 0
    s_cselect_b32 s30, 15360, s21
    s_cbranch_scc0 P3_acq1
    buffer_load_dwordx4 v[100:103], v7, s[24:27], s30 offen offset:0 sc1
    buffer_load_dwordx4 v[104:107], v6, s[24:27], s30 offen offset:0 sc1
    buffer_load_dwordx4 v[108:111], v7, s[24:27], s30 offen offset:1024 sc1
    buffer_load_dwordx4 v[112:115], v6, s[24:27], s30 offen offset:1024 sc1
    buffer_load_dwordx4 v[116:119], v7, s[24:27], s30 offen offset:2048 sc1
    buffer_load_dwordx4 v[120:123], v6, s[24:27], s30 offen offset:2048 sc1
    buffer_load_dwordx4 v[124:127], v7, s[24:27], s30 offen offset:3072 sc1
    buffer_load_dwordx4 v[128:131], v6, s[24:27], s30 offen offset:3072 sc1
    buffer_load_dwordx2 v[132:133], v11, s[24:27], s30 offen offset:0 sc1
    buffer_load_dwordx2 v[134:135], v11, s[24:27], s30 offen offset:128 sc1
    buffer_load_dwordx2 v[136:137], v15, s[24:27], s30 offen offset:0 sc1
    buffer_load_dwordx2 v[138:139], v15, s[24:27], s30 offen offset:128 sc1
    s_branch P3_go1
P3_acq2:
    ds_read_b64 v[4:5], v12
    s_waitcnt lgkmcnt(0)
    v_cmp_eq_u64 vcc, s[0:1], v[4:5]
    s_nop 1
    s_or_b32 s22, s22, vcc_lo
    s_bitcmp1_b32 s22, 0
    s_cselect_b32 s23, 1, 0
    s_cselect_b32 s30, 0, s21
    s_cbranch_scc0 P3_acq2
    buffer_load_dwordx4 v[140:143], v7, s[24:27], s30 offen offset:0 sc1
    buffer_load_dwordx4 v[144:147], v6, s[24:27], s30 offen offset:0 sc1
    buffer_load_dwordx4 v[148:151], v7, s[24:27], s30 offen offset:1024 sc1
    buffer_load_dwordx4 v[152:155], v6, s[24:27], s30 offen offset:1024 sc1
    buffer_load_dwordx4 v[156:159], v7, s[24:27], s30 offen offset:2048 sc1
    buffer_load_dwordx4 v[160:163], v6, s[24:27], s30 offen offset:2048 sc1
    buffer_load_dwordx4 v[164:167], v7, s[24:27], s30 offen offset:3072 sc1
    buffer_load_dwordx4 v[168:171], v6, s[24:27], s30 offen offset:3072 sc1
    buffer_load_dwordx2 v[172:173], v11, s[24:27], s30 offen offset:0 sc1
    buffer_load_dwordx2 v[174:175], v11, s[24:27], s30 offen offset:128 sc1
    buffer_load_dwordx2 v[176:177], v15, s[24:27], s30 offen offset:0 sc1
    buffer_load_dwordx2 v[178:179], v15, s[24:27], s30 offen offset:128 sc1
    s_branch P3_go2
P3:
    s_mov_b32 s16, s44
    s_and_b32 s17, s45, 0xffff
    s_mov_b32 s18, 5242880
    s_mov_b32 s19, 0x20000
    buffer_load_dwordx2 v[4:5], v13, s[96:99], 0 offen sc1
    s_mov_b32 s21, 0x70000000
    s_waitcnt vmcnt(1)
    s_barrier
    ds_read_b64_tr_b16 v[220:221], v9 offset:0
    ds_read_b64_tr_b16 v[222:223], v9 offset:2560
    ds_read_b64_tr_b16 v[224:225], v9 offset:32
    ds_read_b64_tr_b16 v[226:227], v9 offset:2592
    ds_read_b64_tr_b16 v[228:229], v9 offset:64
    ds_read_b64_tr_b16 v[230:231], v9 offset:2624
    ds_read_b64_tr_b16 v[232:233], v9 offset:96
    ds_read_b64_tr_b16 v[234:235], v9 offset:2656
    ds_read_b64_tr_b16 v[236:237], v9 offset:128
    ds_read_b64_tr_b16 v[238:239], v9 offset:2688
    ds_read_b64_tr_b16 v[240:241], v9 offset:5120
    ds_read_b64_tr_b16 v[242:243], v9 offset:7680
    s_waitcnt vmcnt(0)
    v_cmp_ne_u64 vcc, s[0:1], v[4:5]
    s_nop 1
    s_cmp_eq_u64 vcc, 0
    s_cselect_b32 s22, 0xff, 0
P3_acq0:
    ds_read_b64 v[4:5], v12
    s_waitcnt lgkmcnt(0)
    v_cmp_eq_u64 vcc, s[0:1], v[4:5]
    s_nop 1
    s_or_b32 s22, s22, vcc_lo
    s_bitcmp1_b32 s22, 2
    s_cselect_b32 s23, 1, 0
    s_cselect_b32 s30, 10240, s21
    s_cbranch_scc0 P3_acq0
    buffer_load_dwordx4 v[60:63], v7, s[24:27], s30 offen offset:0 sc1
    buffer_load_dwordx4 v[64:67], v6, s[24:27], s30 offen offset:0 sc1
    buffer_load_dwordx4 v[68:71], v7, s[24:27], s30 offen offset:1024 sc1
    buffer_load_dwordx4 v[72:75], v6, s[24:27], s30 offen offset:1024 sc1
    buffer_load_dwordx4 v[76:79], v7, s[24:27], s30 offen offset:2048 sc1
    buffer_load_dwordx4 v[80:83], v6, s[24:27], s30 offen offset:2048 sc1
    buffer_load_dwordx4 v[84:87], v7, s[24:27], s30 offen offset:3072 sc1
    buffer_load_dwordx4 v[88:91], v6, s[24:27], s30 offen offset:3072 sc1
    buffer_load_dwordx2 v[92:93], v11, s[24:27], s30 offen offset:0 sc1
    buffer_load_dwordx2 v[94:95], v11, s[24:27], s30 offen offset:128 sc1
    buffer_load_dwordx2 v[96:97], v15, s[24:27], s30 offen offset:0 sc1
    buffer_load_dwordx2 v[98:99], v15, s[24:27], s30 offen offset:128 sc1
    v_cmp_eq_u64 vcc, s[0:1], v[4:5]
    s_nop 1
    s_or_b32 s22, s22, vcc_lo
    s_bitcmp1_b32 s22, 3
    s_cselect_b32 s23, 1, 0
    s_cselect_b32 s30, 15360, s21
    buffer_load_dwordx4 v[100:103], v7, s[24:27], s30 offen offset:0 sc1
    buffer_load_dwordx4 v[104:107], v6, s[24:27], s30 offen offset:0 sc1
    buffer_load_dwordx4 v[108:111], v7, s[24:27], s30 offen offset:1024 sc1
    buffer_load_dwordx4 v[112:115], v6, s[24:27], s30 offen offset:1024 sc1
    buffer_load_dwordx4 v[116:119], v7, s[24:27], s30 offen offset:2048 sc1
    buffer_load_dwordx4 v[120:123], v6, s[24:27], s30 offen offset:2048 sc1
    buffer_load_dwordx4 v[124:127], v7, s[24:27], s30 offen offset:3072 sc1
    buffer_load_dwordx4 v[128:131], v6, s[24:27], s30 offen offset:3072 sc1
    buffer_load_dwordx2 v[132:133], v11, s[24:27], s30 offen offset:0 sc1
    buffer_load_dwordx2 v[134:135], v11, s[24:27], s30 offen offset:128 sc1
    buffer_load_dwordx2 v[136:137], v15, s[24:27], s30 offen offset:0 sc1
    buffer_load_dwordx2 v[138:139], v15, s[24:27], s30 offen offset:128 sc1
    s_waitcnt vmcnt(22)
    v_mfma_f32_16x16x32_bf16 v[16:19], v[220:223], v[60:63], 0
    ds_read_b64_tr_b16 v[244:245], v9 offset:5152
    v_mfma_f32_16x16x32_bf16 v[20:23], v[220:223], v[64:67], 0
    ds_read_b64_tr_b16 v[246:247], v9 offset:7712
    v_mfma_f32_16x16x32_bf16 v[24:27], v[224:227], v[60:63], 0
    ds_read_b64_tr_b16 v[248:249], v9 offset:5184
    v_mfma_f32_16x16x32_bf16 v[28:31], v[224:227], v[64:67], 0
    ds_read_b64_tr_b16 v[250:251], v9 offset:7744
    v_mfma_f32_16x16x32_bf16 v[32:35], v[228:231], v[60:63], 0
    ds_read_b64_tr_b16 v[220:221], v9 offset:5216
    v_mfma_f32_16x16x32_bf16 v[36:39], v[228:231], v[64:67], 0
    ds_read_b64_tr_b16 v[222:223], v9 offset:7776
    v_mfma_f32_16x16x32_bf16 v[40:43], v[232:235], v[60:63], 0
    ds_read_b64_tr_b16 v[224:225], v9 offset:5248
    v_mfma_f32_16x16x32_bf16 v[44:47], v[232:235], v[64:67], 0
    ds_read_b64_tr_b16 v[226:227], v9 offset:7808
    v_mfma_f32_16x16x32_bf16 v[48:51], v[236:239], v[60:63], 0
    ds_read_b64_tr_b16 v[228:229], v9 offset:10240
    v_mfma_f32_16x16x32_bf16 v[52:55], v[236:239], v[64:67], 0
    ds_read_b64_tr_b16 v[230:231], v9 offset:12800
    s_waitcnt vmcnt(20)
    v_mfma_f32_16x16x32_bf16 v[16:19], v[240:243], v[68:71], v[16:19]
    ds_read_b64_tr_b16 v[232:233], v9 offset:10272
    v_mfma_f32_16x16x32_bf16 v[20:23], v[240:243], v[72:75], v[20:23]
    ds_read_b64_tr_b16 v[234:235], v9 offset:12832
    s_waitcnt lgkmcnt(8)
    v_mfma_f32_16x16x32_bf16 v[24:27], v[244:247], v[68:71], v[24:27]
    ds_read_b64_tr_b16 v[236:237], v9 offset:10304
    v_mfma_f32_16x16x32_bf16 v[28:31], v[244:247], v[72:75], v[28:31]
    ds_read_b64_tr_b16 v[238:239], v9 offset:12864
    v_mfma_f32_16x16x32_bf16 v[32:35], v[248:251], v[68:71], v[32:35]
    ds_read_b64_tr_b16 v[240:241], v9 offset:10336
    v_mfma_f32_16x16x32_bf16 v[36:39], v[248:251], v[72:75], v[36:39]
    ds_read_b64_tr_b16 v[242:243], v9 offset:12896
    s_waitcnt lgkmcnt(8)
    v_mfma_f32_16x16x32_bf16 v[40:43], v[220:223], v[68:71], v[40:43]
    ds_read_b64_tr_b16 v[244:245], v9 offset:10368
    v_mfma_f32_16x16x32_bf16 v[44:47], v[220:223], v[72:75], v[44:47]
    ds_read_b64_tr_b16 v[246:247], v9 offset:12928
    v_mfma_f32_16x16x32_bf16 v[48:51], v[224:227], v[68:71], v[48:51]
    ds_read_b64_tr_b16 v[248:249], v9 offset:15360
    v_mfma_f32_16x16x32_bf16 v[52:55], v[224:227], v[72:75], v[52:55]
    ds_read_b64_tr_b16 v[250:251], v9 offset:17920
    s_waitcnt vmcnt(18)
    s_waitcnt lgkmcnt(8)
    v_mfma_f32_16x16x32_bf16 v[16:19], v[228:231], v[76:79], v[16:19]
    ds_read_b64_tr_b16 v[220:221], v9 offset:15392
    v_mfma_f32_16x16x32_bf16 v[20:23], v[228:231], v[80:83], v[20:23]
    ds_read_b64_tr_b16 v[222:223], v9 offset:17952
    v_mfma_f32_16x16x32_bf16 v[24:27], v[232:235], v[76:79], v[24:27]
    ds_read_b64_tr_b16 v[224:225], v9 offset:15424
    v_mfma_f32_16x16x32_bf16 v[28:31], v[232:235], v[80:83], v[28:31]
    ds_read_b64_tr_b16 v[226:227], v9 offset:17984
    s_waitcnt lgkmcnt(8)
    v_mfma_f32_16x16x32_bf16 v[32:35], v[236:239], v[76:79], v[32:35]
    ds_read_b64_tr_b16 v[228:229], v9 offset:15456
    v_mfma_f32_16x16x32_bf16 v[36:39], v[236:239], v[80:83], v[36:39]
    ds_read_b64_tr_b16 v[230:231], v9 offset:18016
    v_mfma_f32_16x16x32_bf16 v[40:43], v[240:243], v[76:79], v[40:43]
    ds_read_b64_tr_b16 v[232:233], v9 offset:15488
    v_mfma_f32_16x16x32_bf16 v[44:47], v[240:243], v[80:83], v[44:47]
    ds_read_b64_tr_b16 v[234:235], v9 offset:18048
    s_waitcnt lgkmcnt(8)
    v_mfma_f32_16x16x32_bf16 v[48:51], v[244:247], v[76:79], v[48:51]
    ds_read_b64_tr_b16 v[236:237], v9 offset:20480
    v_mfma_f32_16x16x32_bf16 v[52:55], v[244:247], v[80:83], v[52:55]
    ds_read_b64_tr_b16 v[238:239], v9 offset:23040
    s_waitcnt vmcnt(16)
    v_mfma_f32_16x16x32_bf16 v[16:19], v[248:251], v[84:87], v[16:19]
    ds_read_b64_tr_b16 v[240:241], v9 offset:20512
    v_mfma_f32_16x16x32_bf16 v[20:23], v[248:251], v[88:91], v[20:23]
    ds_read_b64_tr_b16 v[242:243], v9 offset:23072
    s_waitcnt lgkmcnt(8)
    v_mfma_f32_16x16x32_bf16 v[24:27], v[220:223], v[84:87], v[24:27]
    ds_read_b64_tr_b16 v[244:245], v9 offset:20544
    v_mfma_f32_16x16x32_bf16 v[28:31], v[220:223], v[88:91], v[28:31]
    ds_read_b64_tr_b16 v[246:247], v9 offset:23104
    v_mfma_f32_16x16x32_bf16 v[32:35], v[224:227], v[84:87], v[32:35]
    ds_read_b64_tr_b16 v[248:249], v9 offset:20576
    v_mfma_f32_16x16x32_bf16 v[36:39], v[224:227], v[88:91], v[36:39]
    ds_read_b64_tr_b16 v[250:251], v9 offset:23136
    s_waitcnt lgkmcnt(8)
    v_mfma_f32_16x16x32_bf16 v[40:43], v[228:231], v[84:87], v[40:43]
    ds_read_b64_tr_b16 v[220:221], v9 offset:20608
    v_mfma_f32_16x16x32_bf16 v[44:47], v[228:231], v[88:91], v[44:47]
    ds_read_b64_tr_b16 v[222:223], v9 offset:23168
    v_mfma_f32_16x16x32_bf16 v[48:51], v[232:235], v[84:87], v[48:51]
    ds_read_b64 v[4:5], v12
    ds_read_b64_tr_b16 v[224:225], v9 offset:25600
    v_mfma_f32_16x16x32_bf16 v[52:55], v[232:235], v[88:91], v[52:55]
    ds_read_b64_tr_b16 v[226:227], v9 offset:28160
    s_waitcnt vmcnt(12)
    s_waitcnt lgkmcnt(9)
    v_mfma_f32_16x16x32_bf16 v[16:19], v[236:239], v[92:95], v[16:19]
    ds_read_b64_tr_b16 v[228:229], v9 offset:25632
    v_mfma_f32_16x16x32_bf16 v[20:23], v[236:239], v[96:99], v[20:23]
    ds_read_b64_tr_b16 v[230:231], v9 offset:28192
    v_mfma_f32_16x16x32_bf16 v[24:27], v[240:243], v[92:95], v[24:27]
    ds_read_b64_tr_b16 v[232:233], v9 offset:25664
    v_mfma_f32_16x16x32_bf16 v[28:31], v[240:243], v[96:99], v[28:31]
    ds_read_b64_tr_b16 v[234:235], v9 offset:28224
    s_waitcnt lgkmcnt(9)
    v_mfma_f32_16x16x32_bf16 v[32:35], v[244:247], v[92:95], v[32:35]
    ds_read_b64_tr_b16 v[236:237], v9 offset:25696
    v_mfma_f32_16x16x32_bf16 v[36:39], v[244:247], v[96:99], v[36:39]
    ds_read_b64_tr_b16 v[238:239], v9 offset:28256
    v_mfma_f32_16x16x32_bf16 v[40:43], v[248:251], v[92:95], v[40:43]
    ds_read_b64_tr_b16 v[240:241], v9 offset:25728
    v_mfma_f32_16x16x32_bf16 v[44:47], v[248:251], v[96:99], v[44:47]
    ds_read_b64_tr_b16 v[242:243], v9 offset:28288
    s_waitcnt lgkmcnt(8)
    v_mfma_f32_16x16x32_bf16 v[48:51], v[220:223], v[92:95], v[48:51]
    ds_read_b64_tr_b16 v[244:245], v9 offset:30720
    v_mfma_f32_16x16x32_bf16 v[52:55], v[220:223], v[96:99], v[52:55]
    ds_read_b64_tr_b16 v[246:247], v9 offset:33280
    s_cmp_eq_u32 s23, 0
    s_cbranch_scc1 P3_acq1
P3_go1:
    s_waitcnt vmcnt(10)
    v_mfma_f32_16x16x32_bf16 v[16:19], v[224:227], v[100:103], v[16:19]
    ds_read_b64_tr_b16 v[248:249], v9 offset:30752
    v_cmp_eq_u64 vcc, s[0:1], v[4:5]
    v_mfma_f32_16x16x32_bf16 v[20:23], v[224:227], v[104:107], v[20:23]
    ds_read_b64_tr_b16 v[250:251], v9 offset:33312
    s_or_b32 s22, s22, vcc_lo
    s_waitcnt lgkmcnt(8)
    v_mfma_f32_16x16x32_bf16 v[24:27], v[228:231], v[100:103], v[24:27]
    ds_read_b64_tr_b16 v[220:221], v9 offset:30784
    s_bitcmp1_b32 s22, 0
    s_cselect_b32 s23, 1, 0
    s_cselect_b32 s30, 0, s21
    v_mfma_f32_16x16x32_bf16 v[28:31], v[228:231], v[104:107], v[28:31]
    ds_read_b64_tr_b16 v[222:223], v9 offset:33344
    buffer_load_dwordx4 v[140:143], v7, s[24:27], s30 offen offset:0 sc1
    v_mfma_f32_16x16x32_bf16 v[32:35], v[232:235], v[100:103], v[32:35]
    ds_read_b64_tr_b16 v[224:225], v9 offset:30816
    buffer_load_dwordx4 v[144:147], v6, s[24:27], s30 offen offset:0 sc1
    v_mfma_f32_16x16x32_bf16 v[36:39], v[232:235], v[104:107], v[36:39]
    ds_read_b64_tr_b16 v[226:227], v9 offset:33376
    buffer_load_dwordx4 v[148:151], v7, s[24:27], s30 offen offset:1024 sc1
    s_waitcnt lgkmcnt(8)
    v_mfma_f32_16x16x32_bf16 v[40:43], v[236:239], v[100:103], v[40:43]
    ds_read_b64_tr_b16 v[228:229], v9 offset:30848
    buffer_load_dwordx4 v[152:155], v6, s[24:27], s30 offen offset:1024 sc1
    v_mfma_f32_16x16x32_bf16 v[44:47], v[236:239], v[104:107], v[44:47]
    ds_read_b64_tr_b16 v[230:231], v9 offset:33408
    buffer_load_dwordx4 v[156:159], v7, s[24:27], s30 offen offset:2048 sc1
    v_mfma_f32_16x16x32_bf16 v[48:51], v[240:243], v[100:103], v[48:51]
    ds_read_b64_tr_b16 v[232:233], v9 offset:35840
    buffer_load_dwordx4 v[160:163], v6, s[24:27], s30 offen offset:2048 sc1
    v_mfma_f32_16x16x32_bf16 v[52:55], v[240:243], v[104:107], v[52:55]
    ds_read_b64_tr_b16 v[234:235], v9 offset:38400
    buffer_load_dwordx4 v[164:167], v7, s[24:27], s30 offen offset:3072 sc1
    s_waitcnt vmcnt(15)
    s_waitcnt lgkmcnt(8)
    v_mfma_f32_16x16x32_bf16 v[16:19], v[244:247], v[108:111], v[16:19]
    ds_read_b64_tr_b16 v[236:237], v9 offset:35872
    buffer_load_dwordx4 v[168:171], v6, s[24:27], s30 offen offset:3072 sc1
    v_mfma_f32_16x16x32_bf16 v[20:23], v[244:247], v[112:115], v[20:23]
    ds_read_b64_tr_b16 v[238:239], v9 offset:38432
    buffer_load_dwordx2 v[172:173], v11, s[24:27], s30 offen offset:0 sc1
    v_mfma_f32_16x16x32_bf16 v[24:27], v[248:251], v[108:111], v[24:27]
    ds_read_b64_tr_b16 v[240:241], v9 offset:35904
    buffer_load_dwordx2 v[174:175], v11, s[24:27], s30 offen offset:128 sc1
    v_mfma_f32_16x16x32_bf16 v[28:31], v[248:251], v[112:115], v[28:31]
    ds_read_b64_tr_b16 v[242:243], v9 offset:38464
    buffer_load_dwordx2 v[176:177], v15, s[24:27], s30 offen offset:0 sc1
    s_waitcnt lgkmcnt(8)
    v_mfma_f32_16x16x32_bf16 v[32:35], v[220:223], v[108:111], v[32:35]
    ds_read_b64_tr_b16 v[244:245], v9 offset:35936
    buffer_load_dwordx2 v[178:179], v15, s[24:27], s30 offen offset:128 sc1
    v_mfma_f32_16x16x32_bf16 v[36:39], v[220:223], v[112:115], v[36:39]
    ds_read_b64_tr_b16 v[246:247], v9 offset:38496
    v_mfma_f32_16x16x32_bf16 v[40:43], v[224:227], v[108:111], v[40:43]
    ds_read_b64_tr_b16 v[248:249], v9 offset:35968
    v_mfma_f32_16x16x32_bf16 v[44:47], v[224:227], v[112:115], v[44:47]
    ds_read_b64_tr_b16 v[250:251], v9 offset:38528
    s_waitcnt lgkmcnt(8)
    v_mfma_f32_16x16x32_bf16 v[48:51], v[228:231], v[108:111], v[48:51]
    ds_read_b64_tr_b16 v[220:221], v9 offset:40960
    v_mfma_f32_16x16x32_bf16 v[52:55], v[228:231], v[112:115], v[52:55]
    ds_read_b64_tr_b16 v[222:223], v9 offset:43520
    s_waitcnt vmcnt(18)
    v_mfma_f32_16x16x32_bf16 v[16:19], v[232:235], v[116:119], v[16:19]
    ds_read_b64_tr_b16 v[224:225], v9 offset:40992
    v_mfma_f32_16x16x32_bf16 v[20:23], v[232:235], v[120:123], v[20:23]
    ds_read_b64_tr_b16 v[226:227], v9 offset:43552
    s_waitcnt lgkmcnt(8)
    v_mfma_f32_16x16x32_bf16 v[24:27], v[236:239], v[116:119], v[24:27]
    ds_read_b64_tr_b16 v[228:229], v9 offset:41024
    v_mfma_f32_16x16x32_bf16 v[28:31], v[236:239], v[120:123], v[28:31]
    ds_read_b64_tr_b16 v[230:231], v9 offset:43584
    v_mfma_f32_16x16x32_bf16 v[32:35], v[240:243], v[116:119], v[32:35]
    ds_read_b64_tr_b16 v[232:233], v9 offset:41056
    v_mfma_f32_16x16x32_bf16 v[36:39], v[240:243], v[120:123], v[36:39]
    ds_read_b64_tr_b16 v[234:235], v9 offset:43616
    s_waitcnt lgkmcnt(8)
    v_mfma_f32_16x16x32_bf16 v[40:43], v[244:247], v[116:119], v[40:43]
    ds_read_b64_tr_b16 v[236:237], v9 offset:41088
    v_mfma_f32_16x16x32_bf16 v[44:47], v[244:247], v[120:123], v[44:47]
    ds_read_b64_tr_b16 v[238:239], v9 offset:43648
    v_mfma_f32_16x16x32_bf16 v[48:51], v[248:251], v[116:119], v[48:51]
    ds_read_b64_tr_b16 v[240:241], v9 offset:46080
    v_mfma_f32_16x16x32_bf16 v[52:55], v[248:251], v[120:123], v[52:55]
    ds_read_b64_tr_b16 v[242:243], v9 offset:48640
    s_waitcnt vmcnt(16)
    s_waitcnt lgkmcnt(8)
    v_mfma_f32_16x16x32_bf16 v[16:19], v[220:223], v[124:127], v[16:19]
    ds_read_b64_tr_b16 v[244:245], v9 offset:46112
    v_mfma_f32_16x16x32_bf16 v[20:23], v[220:223], v[128:131], v[20:23]
    ds_read_b64_tr_b16 v[246:247], v9 offset:48672
    v_mfma_f32_16x16x32_bf16 v[24:27], v[224:227], v[124:127], v[24:27]
    ds_read_b64_tr_b16 v[248:249], v9 offset:46144
    v_mfma_f32_16x16x32_bf16 v[28:31], v[224:227], v[128:131], v[28:31]
    ds_read_b64_tr_b16 v[250:251], v9 offset:48704
    s_waitcnt lgkmcnt(8)
    v_mfma_f32_16x16x32_bf16 v[32:35], v[228:231], v[124:127], v[32:35]
    ds_read_b64_tr_b16 v[220:221], v9 offset:46176
    v_mfma_f32_16x16x32_bf16 v[36:39], v[228:231], v[128:131], v[36:39]
    ds_read_b64_tr_b16 v[222:223], v9 offset:48736
    v_mfma_f32_16x16x32_bf16 v[40:43], v[232:235], v[124:127], v[40:43]
    ds_read_b64_tr_b16 v[224:225], v9 offset:46208
    v_mfma_f32_16x16x32_bf16 v[44:47], v[232:235], v[128:131], v[44:47]
    ds_read_b64_tr_b16 v[226:227], v9 offset:48768
    s_waitcnt lgkmcnt(8)
    v_mfma_f32_16x16x32_bf16 v[48:51], v[236:239], v[124:127], v[48:51]
    ds_read_b64 v[4:5], v12
    ds_read_b64_tr_b16 v[228:229], v8 offset:0
    v_mfma_f32_16x16x32_bf16 v[52:55], v[236:239], v[128:131], v[52:55]
    ds_read_b64_tr_b16 v[230:231], v8 offset:2560
    s_waitcnt vmcnt(12)
    v_mfma_f32_16x16x32_bf16 v[16:19], v[240:243], v[132:135], v[16:19]
    ds_read_b64_tr_b16 v[232:233], v8 offset:32
    v_mfma_f32_16x16x32_bf16 v[20:23], v[240:243], v[136:139], v[20:23]
    ds_read_b64_tr_b16 v[234:235], v8 offset:2592
    s_waitcnt lgkmcnt(9)
    v_mfma_f32_16x16x32_bf16 v[24:27], v[244:247], v[132:135], v[24:27]
    ds_read_b64_tr_b16 v[236:237], v8 offset:64
    v_mfma_f32_16x16x32_bf16 v[28:31], v[244:247], v[136:139], v[28:31]
    ds_read_b64_tr_b16 v[238:239], v8 offset:2624
    v_mfma_f32_16x16x32_bf16 v[32:35], v[248:251], v[132:135], v[32:35]
    ds_read_b64_tr_b16 v[240:241], v8 offset:96
    v_mfma_f32_16x16x32_bf16 v[36:39], v[248:251], v[136:139], v[36:39]
    ds_read_b64_tr_b16 v[242:243], v8 offset:2656
    s_waitcnt lgkmcnt(9)
    v_mfma_f32_16x16x32_bf16 v[40:43], v[220:223], v[132:135], v[40:43]
    ds_read_b64_tr_b16 v[244:245], v8 offset:128
    v_mfma_f32_16x16x32_bf16 v[44:47], v[220:223], v[136:139], v[44:47]
    ds_read_b64_tr_b16 v[246:247], v8 offset:2688
    v_mfma_f32_16x16x32_bf16 v[48:51], v[224:227], v[132:135], v[48:51]
    ds_read_b64_tr_b16 v[248:249], v8 offset:5120
    v_mfma_f32_16x16x32_bf16 v[52:55], v[224:227], v[136:139], v[52:55]
    ds_read_b64_tr_b16 v[250:251], v8 offset:7680
    s_cmp_eq_u32 s23, 0
    s_cbranch_scc1 P3_acq2
P3_go2:
    s_waitcnt lgkmcnt(12)
    s_waitcnt vmcnt(10)
    s_waitcnt lgkmcnt(8)
    v_mfma_f32_16x16x32_bf16 v[16:19], v[228:231], v[140:143], v[16:19]
    ds_read_b64_tr_b16 v[220:221], v8 offset:5152
    v_cmp_eq_u64 vcc, s[0:1], v[4:5]
    v_mfma_f32_16x16x32_bf16 v[20:23], v[228:231], v[144:147], v[20:23]
    ds_read_b64_tr_b16 v[222:223], v8 offset:7712
    s_or_b32 s22, s22, vcc_lo
    v_mfma_f32_16x16x32_bf16 v[24:27], v[232:235], v[140:143], v[24:27]
    ds_read_b64_tr_b16 v[224:225], v8 offset:5184
    s_bitcmp1_b32 s22, 1
    s_cselect_b32 s23, 1, 0
    s_cselect_b32 s30, 5120, s21
    v_mfma_f32_16x16x32_bf16 v[28:31], v[232:235], v[144:147], v[28:31]
    ds_read_b64_tr_b16 v[226:227], v8 offset:7744
    buffer_load_dwordx4 v[180:183], v7, s[24:27], s30 offen offset:0 sc1
    s_waitcnt lgkmcnt(8)
    v_mfma_f32_16x16x32_bf16 v[32:35], v[236:239], v[140:143], v[32:35]
    ds_read_b64_tr_b16 v[228:229], v8 offset:5216
    buffer_load_dwordx4 v[184:187], v6, s[24:27], s30 offen offset:0 sc1
    v_mfma_f32_16x16x32_bf16 v[36:39], v[236:239], v[144:147], v[36:39]
    ds_read_b64_tr_b16 v[230:231], v8 offset:7776
    buffer_load_dwordx4 v[188:191], v7, s[24:27], s30 offen offset:1024 sc1
    v_mfma_f32_16x16x32_bf16 v[40:43], v[240:243], v[140:143], v[40:43]
    ds_read_b64_tr_b16 v[232:233], v8 offset:5248
    buffer_load_dwordx4 v[192:195], v6, s[24:27], s30 offen offset:1024 sc1
    v_mfma_f32_16x16x32_bf16 v[44:47], v[240:243], v[144:147], v[44:47]
    ds_read_b64_tr_b16 v[234:235], v8 offset:7808
    buffer_load_dwordx4 v[196:199], v7, s[24:27], s30 offen offset:2048 sc1
    s_waitcnt lgkmcnt(8)
    v_mfma_f32_16x16x32_bf16 v[48:51], v[244:247], v[140:143], v[48:51]
    ds_read_b64_tr_b16 v[236:237], v8 offset:10240
    buffer_load_dwordx4 v[200:203], v6, s[24:27], s30 offen offset:2048 sc1
    v_mfma_f32_16x16x32_bf16 v[52:55], v[244:247], v[144:147], v[52:55]
    ds_read_b64_tr_b16 v[238:239], v8 offset:12800
    buffer_load_dwordx4 v[204:207], v7, s[24:27], s30 offen offset:3072 sc1
    s_waitcnt vmcnt(15)
    v_mfma_f32_16x16x32_bf16 v[16:19], v[248:251], v[148:151], v[16:19]
    ds_read_b64_tr_b16 v[240:241], v8 offset:10272
    buffer_load_dwordx4 v[208:211], v6, s[24:27], s30 offen offset:3072 sc1
    v_mfma_f32_16x16x32_bf16 v[20:23], v[248:251], v[152:155], v[20:23]
    ds_read_b64_tr_b16 v[242:243], v8 offset:12832
    buffer_load_dwordx2 v[212:213], v11, s[24:27], s30 offen offset:0 sc1
    s_waitcnt lgkmcnt(8)
    v_mfma_f32_16x16x32_bf16 v[24:27], v[220:223], v[148:151], v[24:27]
    ds_read_b64_tr_b16 v[244:245], v8 offset:10304
    buffer_load_dwordx2 v[214:215], v11, s[24:27], s30 offen offset:128 sc1
    v_mfma_f32_16x16x32_bf16 v[28:31], v[220:223], v[152:155], v[28:31]
    ds_read_b64_tr_b16 v[246:247], v8 offset:12864
    buffer_load_dwordx2 v[216:217], v15, s[24:27], s30 offen offset:0 sc1
    v_mfma_f32_16x16x32_bf16 v[32:35], v[224:227], v[148:151], v[32:35]
    ds_read_b64_tr_b16 v[248:249], v8 offset:10336
    buffer_load_dwordx2 v[218:219], v15, s[24:27], s30 offen offset:128 sc1
    v_mfma_f32_16x16x32_bf16 v[36:39], v[224:227], v[152:155], v[36:39]
    ds_read_b64_tr_b16 v[250:251], v8 offset:12896
    s_waitcnt lgkmcnt(8)
    v_mfma_f32_16x16x32_bf16 v[40:43], v[228:231], v[148:151], v[40:43]
    ds_read_b64_tr_b16 v[220:221], v8 offset:10368
    v_mfma_f32_16x16x32_bf16 v[44:47], v[228:231], v[152:155], v[44:47]
    ds_read_b64_tr_b16 v[222:223], v8 offset:12928
    v_mfma_f32_16x16x32_bf16 v[48:51], v[232:235], v[148:151], v[48:51]
    ds_read_b64_tr_b16 v[224:225], v8 offset:15360
    v_mfma_f32_16x16x32_bf16 v[52:55], v[232:235], v[152:155], v[52:55]
    ds_read_b64_tr_b16 v[226:227], v8 offset:17920
    s_waitcnt vmcnt(18)
    s_waitcnt lgkmcnt(8)
    v_mfma_f32_16x16x32_bf16 v[16:19], v[236:239], v[156:159], v[16:19]
    ds_read_b64_tr_b16 v[228:229], v8 offset:15392
    v_mfma_f32_16x16x32_bf16 v[20:23], v[236:239], v[160:163], v[20:23]
    ds_read_b64_tr_b16 v[230:231], v8 offset:17952
    v_mfma_f32_16x16x32_bf16 v[24:27], v[240:243], v[156:159], v[24:27]
    ds_read_b64_tr_b16 v[232:233], v8 offset:15424
    v_mfma_f32_16x16x32_bf16 v[28:31], v[240:243], v[160:163], v[28:31]
    ds_read_b64_tr_b16 v[234:235], v8 offset:17984
    s_waitcnt lgkmcnt(8)
    v_mfma_f32_16x16x32_bf16 v[32:35], v[244:247], v[156:159], v[32:35]
    ds_read_b64_tr_b16 v[236:237], v8 offset:15456
    v_mfma_f32_16x16x32_bf16 v[36:39], v[244:247], v[160:163], v[36:39]
    ds_read_b64_tr_b16 v[238:239], v8 offset:18016
    v_mfma_f32_16x16x32_bf16 v[40:43], v[248:251], v[156:159], v[40:43]
    ds_read_b64_tr_b16 v[240:241], v8 offset:15488
    v_mfma_f32_16x16x32_bf16 v[44:47], v[248:251], v[160:163], v[44:47]
    ds_read_b64_tr_b16 v[242:243], v8 offset:18048
    s_waitcnt lgkmcnt(8)
    v_mfma_f32_16x16x32_bf16 v[48:51], v[220:223], v[156:159], v[48:51]
    ds_read_b64_tr_b16 v[244:245], v8 offset:20480
    v_mfma_f32_16x16x32_bf16 v[52:55], v[220:223], v[160:163], v[52:55]
    ds_read_b64_tr_b16 v[246:247], v8 offset:23040
    s_waitcnt vmcnt(16)
    v_mfma_f32_16x16x32_bf16 v[16:19], v[224:227], v[164:167], v[16:19]
    ds_read_b64_tr_b16 v[248:249], v8 offset:20512
    v_mfma_f32_16x16x32_bf16 v[20:23], v[224:227], v[168:171], v[20:23]
    ds_read_b64_tr_b16 v[250:251], v8 offset:23072
    s_waitcnt lgkmcnt(8)
    v_mfma_f32_16x16x32_bf16 v[24:27], v[228:231], v[164:167], v[24:27]
    ds_read_b64_tr_b16 v[220:221], v8 offset:20544
    v_mfma_f32_16x16x32_bf16 v[28:31], v[228:231], v[168:171], v[28:31]
    ds_read_b64_tr_b16 v[222:223], v8 offset:23104
    v_mfma_f32_16x16x32_bf16 v[32:35], v[232:235], v[164:167], v[32:35]
    ds_read_b64_tr_b16 v[224:225], v8 offset:20576
    v_mfma_f32_16x16x32_bf16 v[36:39], v[232:235], v[168:171], v[36:39]
    ds_read_b64_tr_b16 v[226:227], v8 offset:23136
    s_waitcnt lgkmcnt(8)
    v_mfma_f32_16x16x32_bf16 v[40:43], v[236:239], v[164:167], v[40:43]
    ds_read_b64_tr_b16 v[228:229], v8 offset:20608
    v_mfma_f32_16x16x32_bf16 v[44:47], v[236:239], v[168:171], v[44:47]
    ds_read_b64_tr_b16 v[230:231], v8 offset:23168
    v_mfma_f32_16x16x32_bf16 v[48:51], v[240:243], v[164:167], v[48:51]
    ds_read_b64_tr_b16 v[232:233], v8 offset:25600
    v_mfma_f32_16x16x32_bf16 v[52:55], v[240:243], v[168:171], v[52:55]
    ds_read_b64_tr_b16 v[234:235], v8 offset:28160
    s_waitcnt vmcnt(12)
    s_waitcnt lgkmcnt(8)
    v_mfma_f32_16x16x32_bf16 v[16:19], v[244:247], v[172:175], v[16:19]
    ds_read_b64_tr_b16 v[236:237], v8 offset:25632
    v_mfma_f32_16x16x32_bf16 v[20:23], v[244:247], v[176:179], v[20:23]
    ds_read_b64_tr_b16 v[238:239], v8 offset:28192
    v_mfma_f32_16x16x32_bf16 v[24:27], v[248:251], v[172:175], v[24:27]
    ds_read_b64_tr_b16 v[240:241], v8 offset:25664
    v_mfma_f32_16x16x32_bf16 v[28:31], v[248:251], v[176:179], v[28:31]
    ds_read_b64_tr_b16 v[242:243], v8 offset:28224
    s_waitcnt lgkmcnt(8)
    v_mfma_f32_16x16x32_bf16 v[32:35], v[220:223], v[172:175], v[32:35]
    ds_read_b64_tr_b16 v[244:245], v8 offset:25696
    v_mfma_f32_16x16x32_bf16 v[36:39], v[220:223], v[176:179], v[36:39]
    ds_read_b64_tr_b16 v[246:247], v8 offset:28256
    v_mfma_f32_16x16x32_bf16 v[40:43], v[224:227], v[172:175], v[40:43]
    ds_read_b64_tr_b16 v[248:249], v8 offset:25728
    v_mfma_f32_16x16x32_bf16 v[44:47], v[224:227], v[176:179], v[44:47]
    ds_read_b64_tr_b16 v[250:251], v8 offset:28288
    s_waitcnt lgkmcnt(8)
    v_mfma_f32_16x16x32_bf16 v[48:51], v[228:231], v[172:175], v[48:51]
    ds_read_b64_tr_b16 v[220:221], v8 offset:30720
    v_mfma_f32_16x16x32_bf16 v[52:55], v[228:231], v[176:179], v[52:55]
    ds_read_b64_tr_b16 v[222:223], v8 offset:33280
    s_cmp_eq_u32 s23, 0
    s_cbranch_scc1 P3_acq3
P3_go3:
    s_waitcnt vmcnt(10)
    v_mfma_f32_16x16x32_bf16 v[16:19], v[232:235], v[180:183], v[16:19]
    ds_read_b64_tr_b16 v[224:225], v8 offset:30752
    v_mfma_f32_16x16x32_bf16 v[20:23], v[232:235], v[184:187], v[20:23]
    ds_read_b64_tr_b16 v[226:227], v8 offset:33312
    s_waitcnt lgkmcnt(8)
    v_mfma_f32_16x16x32_bf16 v[24:27], v[236:239], v[180:183], v[24:27]
    ds_read_b64_tr_b16 v[228:229], v8 offset:30784
    v_mfma_f32_16x16x32_bf16 v[28:31], v[236:239], v[184:187], v[28:31]
    ds_read_b64_tr_b16 v[230:231], v8 offset:33344
    v_mfma_f32_16x16x32_bf16 v[32:35], v[240:243], v[180:183], v[32:35]
    ds_read_b64_tr_b16 v[232:233], v8 offset:30816
    v_mfma_f32_16x16x32_bf16 v[36:39], v[240:243], v[184:187], v[36:39]
    ds_read_b64_tr_b16 v[234:235], v8 offset:33376
    s_waitcnt lgkmcnt(8)
    v_mfma_f32_16x16x32_bf16 v[40:43], v[244:247], v[180:183], v[40:43]
    ds_read_b64_tr_b16 v[236:237], v8 offset:30848
    v_mfma_f32_16x16x32_bf16 v[44:47], v[244:247], v[184:187], v[44:47]
    ds_read_b64_tr_b16 v[238:239], v8 offset:33408
    v_mfma_f32_16x16x32_bf16 v[48:51], v[248:251], v[180:183], v[48:51]
    ds_read_b64_tr_b16 v[240:241], v8 offset:35840
    v_mfma_f32_16x16x32_bf16 v[52:55], v[248:251], v[184:187], v[52:55]
    ds_read_b64_tr_b16 v[242:243], v8 offset:38400
    s_waitcnt vmcnt(8)
    s_waitcnt lgkmcnt(8)
    v_mfma_f32_16x16x32_bf16 v[16:19], v[220:223], v[188:191], v[16:19]
    ds_read_b64_tr_b16 v[244:245], v8 offset:35872
    v_mfma_f32_16x16x32_bf16 v[20:23], v[220:223], v[192:195], v[20:23]
    ds_read_b64_tr_b16 v[246:247], v8 offset:38432
    v_mfma_f32_16x16x32_bf16 v[24:27], v[224:227], v[188:191], v[24:27]
    ds_read_b64_tr_b16 v[248:249], v8 offset:35904
    v_mfma_f32_16x16x32_bf16 v[28:31], v[224:227], v[192:195], v[28:31]
    ds_read_b64_tr_b16 v[250:251], v8 offset:38464
    s_waitcnt lgkmcnt(8)
    v_mfma_f32_16x16x32_bf16 v[32:35], v[228:231], v[188:191], v[32:35]
    ds_read_b64_tr_b16 v[220:221], v8 offset:35936
    v_mfma_f32_16x16x32_bf16 v[36:39], v[228:231], v[192:195], v[36:39]
    ds_read_b64_tr_b16 v[222:223], v8 offset:38496
    v_mfma_f32_16x16x32_bf16 v[40:43], v[232:235], v[188:191], v[40:43]
    ds_read_b64_tr_b16 v[224:225], v8 offset:35968
    v_mfma_f32_16x16x32_bf16 v[44:47], v[232:235], v[192:195], v[44:47]
    ds_read_b64_tr_b16 v[226:227], v8 offset:38528
    s_waitcnt lgkmcnt(8)
    v_mfma_f32_16x16x32_bf16 v[48:51], v[236:239], v[188:191], v[48:51]
    ds_read_b64_tr_b16 v[228:229], v8 offset:40960
    v_mfma_f32_16x16x32_bf16 v[52:55], v[236:239], v[192:195], v[52:55]
    ds_read_b64_tr_b16 v[230:231], v8 offset:43520
    s_waitcnt vmcnt(6)
    v_mfma_f32_16x16x32_bf16 v[16:19], v[240:243], v[196:199], v[16:19]
    ds_read_b64_tr_b16 v[232:233], v8 offset:40992
    v_mfma_f32_16x16x32_bf16 v[20:23], v[240:243], v[200:203], v[20:23]
    ds_read_b64_tr_b16 v[234:235], v8 offset:43552
    s_waitcnt lgkmcnt(8)
    v_mfma_f32_16x16x32_bf16 v[24:27], v[244:247], v[196:199], v[24:27]
    ds_read_b64_tr_b16 v[236:237], v8 offset:41024
    v_mfma_f32_16x16x32_bf16 v[28:31], v[244:247], v[200:203], v[28:31]
    ds_read_b64_tr_b16 v[238:239], v8 offset:43584
    v_mfma_f32_16x16x32_bf16 v[32:35], v[248:251], v[196:199], v[32:35]
    ds_read_b64_tr_b16 v[240:241], v8 offset:41056
    v_mfma_f32_16x16x32_bf16 v[36:39], v[248:251], v[200:203], v[36:39]
    ds_read_b64_tr_b16 v[242:243], v8 offset:43616
    s_waitcnt lgkmcnt(8)
    v_mfma_f32_16x16x32_bf16 v[40:43], v[220:223], v[196:199], v[40:43]
    ds_read_b64_tr_b16 v[244:245], v8 offset:41088
    v_mfma_f32_16x16x32_bf16 v[44:47], v[220:223], v[200:203], v[44:47]
    ds_read_b64_tr_b16 v[246:247], v8 offset:43648
    v_mfma_f32_16x16x32_bf16 v[48:51], v[224:227], v[196:199], v[48:51]
    ds_read_b64_tr_b16 v[248:249], v8 offset:46080
    v_mfma_f32_16x16x32_bf16 v[52:55], v[224:227], v[200:203], v[52:55]
    ds_read_b64_tr_b16 v[250:251], v8 offset:48640
    s_waitcnt vmcnt(4)
    s_waitcnt lgkmcnt(8)
    v_mfma_f32_16x16x32_bf16 v[16:19], v[228:231], v[204:207], v[16:19]
    ds_read_b64_tr_b16 v[220:221], v8 offset:46112
    v_mfma_f32_16x16x32_bf16 v[20:23], v[228:231], v[208:211], v[20:23]
    ds_read_b64_tr_b16 v[222:223], v8 offset:48672
    v_mfma_f32_16x16x32_bf16 v[24:27], v[232:235], v[204:207], v[24:27]
    ds_read_b64_tr_b16 v[224:225], v8 offset:46144
    v_mfma_f32_16x16x32_bf16 v[28:31], v[232:235], v[208:211], v[28:31]
    ds_read_b64_tr_b16 v[226:227], v8 offset:48704
    s_waitcnt lgkmcnt(8)
    v_mfma_f32_16x16x32_bf16 v[32:35], v[236:239], v[204:207], v[32:35]
    ds_read_b64_tr_b16 v[228:229], v8 offset:46176
    v_mfma_f32_16x16x32_bf16 v[36:39], v[236:239], v[208:211], v[36:39]
    ds_read_b64_tr_b16 v[230:231], v8 offset:48736
    v_mfma_f32_16x16x32_bf16 v[40:43], v[240:243], v[204:207], v[40:43]
    ds_read_b64_tr_b16 v[232:233], v8 offset:46208
    v_mfma_f32_16x16x32_bf16 v[44:47], v[240:243], v[208:211], v[44:47]
    ds_read_b64_tr_b16 v[234:235], v8 offset:48768
    s_waitcnt lgkmcnt(8)
    v_mfma_f32_16x16x32_bf16 v[48:51], v[244:247], v[204:207], v[48:51]
    v_mfma_f32_16x16x32_bf16 v[52:55], v[244:247], v[208:211], v[52:55]
    s_waitcnt vmcnt(0)
    v_mfma_f32_16x16x32_bf16 v[16:19], v[248:251], v[212:215], v[16:19]
    v_mfma_f32_16x16x32_bf16 v[20:23], v[248:251], v[216:219], v[20:23]
    s_waitcnt lgkmcnt(4)
    v_mfma_f32_16x16x32_bf16 v[24:27], v[220:223], v[212:215], v[24:27]
    v_mfma_f32_16x16x32_bf16 v[28:31], v[220:223], v[216:219], v[28:31]
    v_mfma_f32_16x16x32_bf16 v[32:35], v[224:227], v[212:215], v[32:35]
    v_mfma_f32_16x16x32_bf16 v[36:39], v[224:227], v[216:219], v[36:39]
    s_waitcnt lgkmcnt(0)
    v_mfma_f32_16x16x32_bf16 v[40:43], v[228:231], v[212:215], v[40:43]
    v_mfma_f32_16x16x32_bf16 v[44:47], v[228:231], v[216:219], v[44:47]
    v_mfma_f32_16x16x32_bf16 v[48:51], v[232:235], v[212:215], v[48:51]
    v_mfma_f32_16x16x32_bf16 v[52:55], v[232:235], v[216:219], v[52:55]
    s_mov_b32 s12, 40960
    v_cvt_pk_bf16_f32 v60, v16, v17
    v_cvt_pk_bf16_f32 v61, v18, v19
    v_cvt_pk_bf16_f32 v62, v24, v25
    v_cvt_pk_bf16_f32 v63, v26, v27
    v_cvt_pk_bf16_f32 v64, v32, v33
    v_cvt_pk_bf16_f32 v65, v34, v35
    v_cvt_pk_bf16_f32 v66, v40, v41
    v_cvt_pk_bf16_f32 v67, v42, v43
    v_cvt_pk_bf16_f32 v68, v48, v49
    v_cvt_pk_bf16_f32 v69, v50, v51
    v_permlane16_swap_b32 v60, v62
    v_permlane16_swap_b32 v61, v63
    v_permlane16_swap_b32 v64, v66
    v_permlane16_swap_b32 v65, v67
    buffer_store_dwordx4 v[60:63], v58, s[16:19], 0 offen
    buffer_store_dwordx4 v[64:67], v58, s[16:19], 0 offen offset:64
    buffer_store_dwordx2 v[68:69], v59, s[16:19], 0 offen offset:128
    v_cvt_pk_bf16_f32 v72, v20, v21
    v_cvt_pk_bf16_f32 v73, v22, v23
    v_cvt_pk_bf16_f32 v74, v28, v29
    v_cvt_pk_bf16_f32 v75, v30, v31
    v_cvt_pk_bf16_f32 v76, v36, v37
    v_cvt_pk_bf16_f32 v77, v38, v39
    v_cvt_pk_bf16_f32 v78, v44, v45
    v_cvt_pk_bf16_f32 v79, v46, v47
    v_cvt_pk_bf16_f32 v80, v52, v53
    v_cvt_pk_bf16_f32 v81, v54, v55
    v_permlane16_swap_b32 v72, v74
    v_permlane16_swap_b32 v73, v75
    v_permlane16_swap_b32 v76, v78
    v_permlane16_swap_b32 v77, v79
    buffer_store_dwordx4 v[72:75], v58, s[16:19], s12 offen
    buffer_store_dwordx4 v[76:79], v58, s[16:19], s12 offen offset:64
    buffer_store_dwordx2 v[80:81], v59, s[16:19], s12 offen offset:128
K_end2:
K_end:
    s_endpgm
P3_acq3:
    ds_read_b64 v[4:5], v12
    s_waitcnt lgkmcnt(0)
    v_cmp_eq_u64 vcc, s[0:1], v[4:5]
    s_nop 1
    s_or_b32 s22, s22, vcc_lo
    s_bitcmp1_b32 s22, 1
    s_cselect_b32 s23, 1, 0
    s_cselect_b32 s30, 5120, s21
    s_cbranch_scc0 P3_acq3
    buffer_load_dwordx4 v[180:183], v7, s[24:27], s30 offen offset:0 sc1
    buffer_load_dwordx4 v[184:187], v6, s[24:27], s30 offen offset:0 sc1
    buffer_load_dwordx4 v[188:191], v7, s[24:27], s30 offen offset:1024 sc1
    buffer_load_dwordx4 v[192:195], v6, s[24:27], s30 offen offset:1024 sc1
    buffer_load_dwordx4 v[196:199], v7, s[24:27], s30 offen offset:2048 sc1
    buffer_load_dwordx4 v[200:203], v6, s[24:27], s30 offen offset:2048 sc1
    buffer_load_dwordx4 v[204:207], v7, s[24:27], s30 offen offset:3072 sc1
    buffer_load_dwordx4 v[208:211], v6, s[24:27], s30 offen offset:3072 sc1
    buffer_load_dwordx2 v[212:213], v11, s[24:27], s30 offen offset:0 sc1
    buffer_load_dwordx2 v[214:215], v11, s[24:27], s30 offen offset:128 sc1
    buffer_load_dwordx2 v[216:217], v15, s[24:27], s30 offen offset:0 sc1
    buffer_load_dwordx2 v[218:219], v15, s[24:27], s30 offen offset:128 sc1
    s_branch P3_go3
K_last:
    s_endpgm
.section .rodata,"a"
.p2align 6
.amdhsa_kernel concat_heads__sliding_local_dilated__sliding_block__prompt_kernel
  .amdhsa_next_free_vgpr 256
  .amdhsa_next_free_sgpr 102
  .amdhsa_accum_offset 256
  .amdhsa_group_segment_fixed_size 0
  .amdhsa_kernarg_size 72
  .amdhsa_user_sgpr_count 2
  .amdhsa_user_sgpr_kernarg_segment_ptr 1
  .amdhsa_system_sgpr_workgroup_id_x 1
.end_amdhsa_kernel
```
